```python
import torch

def _softmax(x, axis=-1):
    return torch.softmax(x, dim=axis)
def _gelu(x):
    return torch.nn.functional.gelu(x, approximate="tanh")
def _silu(x):
    return torch.nn.functional.silu(x)
def _sigmoid(x):
    return torch.sigmoid(x)
def _layernorm(x, axis=-1, eps=1e-5):
    m = x.mean(dim=axis, keepdim=True)
    v = x.var(dim=axis, keepdim=True, unbiased=False)
    return (x - m) / torch.sqrt(v + eps)
def _scatter_add(tgt, idx, src, axis=0):
    return tgt.clone().index_add_(axis, idx, src)
def _segment_sum(src, seg, n):
    out = torch.zeros((n,) + src.shape[1:], dtype=src.dtype)
    return out.index_add_(0, seg, src)
def _pad(x, pw):
    flat = tuple(v for pair in reversed(pw) for v in pair)
    return torch.nn.functional.pad(x, flat)

kernel_name = 'gated_mix__ssm_conv_s4d__ssm_conv_s5__prompt'

def setup_inputs():

    _w = (lambda a: (lambda t: t.to(torch.bfloat16) if t.is_floating_point() else t)(torch.as_tensor(a)))
    def _A_setup():
        Bsz, L, D, N = 1, 2048, 512, 128
        return {
            "u": _w((lambda *s: torch.randn(*s, dtype=torch.bfloat16) * 0.05)(Bsz, L, D)),
            "log_A_real": _w((lambda *s: torch.randn(*s, dtype=torch.bfloat16) * 3.2)(D, N) * 0.5),
            "A_imag": _w((lambda *s: torch.randn(*s, dtype=torch.bfloat16) * 0.05)(D, N) * 3.14),
            "C_real": _w((lambda *s: torch.randn(*s, dtype=torch.bfloat16) * 0.1)(D, N) / N ** 0.5),
            "C_imag": _w((lambda *s: torch.randn(*s, dtype=torch.bfloat16) * 0.1)(D, N) / N ** 0.5),
            "log_dt": _w((lambda *s: torch.randn(*s, dtype=torch.bfloat16) * 0.05)(D) * 0.5 - 4.0),
            "D_skip": _w((lambda *s: torch.randn(*s, dtype=torch.bfloat16) * 0.05)(D)),
        }
    _A_in = _A_setup()

    def _B_setup():
        B, S, D = 1, 2048, 512
        P = D
        Lambda_re = -0.5 * (lambda _x: torch.exp(torch.as_tensor(_x)))((lambda *s: torch.randn(*s, dtype=torch.bfloat16) * 0.2)(P))
        Lambda_im = (lambda *s: torch.randn(*s, dtype=torch.bfloat16) * 0.4)(P) * 1.0
        B_re = (lambda *s: torch.randn(*s, dtype=torch.bfloat16) * 0.2)(P, D) * (D ** -0.5)
        B_im = (lambda *s: torch.randn(*s, dtype=torch.bfloat16) * 0.2)(P, D) * (D ** -0.5)
        C_re = (lambda *s: torch.randn(*s, dtype=torch.bfloat16) * 0.2)(D, P) * (P ** -0.5)
        C_im = (lambda *s: torch.randn(*s, dtype=torch.bfloat16) * 0.2)(D, P) * (P ** -0.5)
        log_dt = (lambda *s: torch.randn(*s, dtype=torch.bfloat16) * 0.2)(P) * 0.3 - 2.0
        Dskip = (lambda *s: torch.randn(*s, dtype=torch.bfloat16) * 0.05)(D)
        return {
            "x": _w((lambda *s: torch.randn(*s, dtype=torch.bfloat16) * 0.05)(B, S, D)),
            "Lambda_re": _w(Lambda_re),
            "Lambda_im": _w(Lambda_im),
            "B_re": _w(B_re),
            "B_im": _w(B_im),
            "C_re": _w(C_re),
            "C_im": _w(C_im),
            "log_dt": _w(log_dt),
            "Dskip": _w(Dskip),
        }
    _B_in = _B_setup()

    return {
        "A_u": _A_in["u"],
        "A_log_A_real": _A_in["log_A_real"],
        "A_A_imag": _A_in["A_imag"],
        "A_C_real": _A_in["C_real"],
        "A_C_imag": _A_in["C_imag"],
        "A_log_dt": _A_in["log_dt"],
        "A_D_skip": _A_in["D_skip"],
        "B_x": _B_in["x"],
        "B_Lambda_re": _B_in["Lambda_re"],
        "B_Lambda_im": _B_in["Lambda_im"],
        "B_B_re": _B_in["B_re"],
        "B_B_im": _B_in["B_im"],
        "B_C_re": _B_in["C_re"],
        "B_C_im": _B_in["C_im"],
        "B_log_dt": _B_in["log_dt"],
        "B_Dskip": _B_in["Dskip"],
        "gate_w": _w((lambda *s: torch.randn(*s, dtype=torch.bfloat16) * 0.05)(512) * 16.0),
    }

def reference(A_u, A_log_A_real, A_A_imag, A_C_real, A_C_imag, A_log_dt, A_D_skip, B_x, B_Lambda_re, B_Lambda_im, B_B_re, B_B_im, B_C_re, B_C_im, B_log_dt, B_Dskip, gate_w):
    def _A_ref(u, log_A_real, A_imag, C_real, C_imag, log_dt, D_skip):
        L = u.shape[1]
        dt = torch.exp(log_dt)
        A = -torch.exp(log_A_real) + 1j * A_imag
        C = (C_real + 1j * C_imag) * dt[:, None]
        pos = (lambda x, dt: x.to(dt))(torch.arange(L), log_dt.dtype)
        P = torch.exp((A * dt[:, None])[:, :, None] * pos[None, None, :])
        K = 2.0 * torch.einsum("dn,dnl->dl", C, P).real
        L2 = 2 * L
        u_t = (lambda x, *d: x.permute(*d))(u, 0, 2, 1)
        Kf = (lambda x, *a, **k: torch.fft.rfft(x.float(), *a, **k))(K, L2)
        Uf = (lambda x, *a, **k: torch.fft.rfft(x.float(), *a, **k))(u_t, L2)
        y = (lambda x, *a, **k: torch.fft.irfft(x, *a, **k).to(torch.bfloat16))(Uf * Kf[None, :, :], L2)[:, :, :L]
        y = (lambda x, *d: x.permute(*d))(y, 0, 2, 1)
        return y + u * D_skip[None, None, :]

    def _B_ref(x, Lambda_re, Lambda_im, B_re, B_im, C_re, C_im, log_dt, Dskip):
        Bsz, L, H = x.shape
        Lam = Lambda_re + 1j * Lambda_im
        Bmat = B_re + 1j * B_im
        Cmat = C_re + 1j * C_im
        dt = torch.exp(log_dt)
        Lam_bar = torch.exp(dt * Lam)
        B_bar = ((Lam_bar - 1.0) / Lam)[:, None] * Bmat
        Bu = torch.einsum("bld,pd->blp", x + 0j, B_bar)
        h = torch.zeros_like(Bu[:, 0, :])
        hs = []
        for t in range(L):
            h = Lam_bar[None, :] * h + Bu[:, t, :]
            hs.append(h)
        hseq = torch.stack(hs, 1)
        y = 2.0 * torch.einsum("blp,dp->bld", hseq, Cmat).real + x * Dskip[None, None, :]
        return y

    x = A_u
    g = _sigmoid((x * gate_w).sum(-1, keepdims=True))
    a = _A_ref(x, A_log_A_real, A_A_imag, A_C_real, A_C_imag, A_log_dt, A_D_skip)
    b = _B_ref(x, B_Lambda_re, B_Lambda_im, B_B_re, B_B_im, B_C_re, B_C_im, B_log_dt, B_Dskip)
    return g * a + (1 - g) * b
```

```asm
; @launch grid=(512,1,1) block=(256,1,1) lds=76672
.amdgcn_target "amdgcn-amd-amdhsa--gfx950"
.text
.globl gated_mix__ssm_conv_s4d__ssm_conv_s5__prompt_kernel
.p2align 8
.type gated_mix__ssm_conv_s4d__ssm_conv_s5__prompt_kernel,@function
gated_mix__ssm_conv_s4d__ssm_conv_s5__prompt_kernel:
    s_cmp_ge_u32 s2, 512
    s_cbranch_scc1 L_end1
    s_load_dwordx16 s[8:23], s[0:1], 0
    s_load_dwordx16 s[24:39], s[0:1], 64
    s_load_dwordx8 s[40:47], s[0:1], 128
    v_lshrrev_b32 v4, 6, v0
    v_and_b32 v1, 63, v0
    v_readfirstlane_b32 s50, v4
    v_and_b32 v2, 31, v0
    v_bfe_u32 v3, v0, 5, 1
    s_cmp_lt_u32 s2, 256
    s_cbranch_scc1 L_conv
    s_and_b32 s51, s2, 7
    s_bfe_u32 s3, s2, 0x10007
    s_lshl_b32 s4, s3, 3
    s_add_u32 s51, s51, s4
    s_bfe_u32 s52, s2, 0x40003
    s_lshl_b32 s3, s3, 2
    s_add_u32 s3, s3, s52
    s_lshl_b32 s68, s3, 7
    v_and_b32 v18, 7, v1
    v_lshrrev_b32 v19, 4, v1
    v_xor_b32 v18, v18, v19
    v_lshlrev_b32 v18, 4, v18
    v_bfe_u32 v19, v1, 3, 2
    v_lshl_add_u32 v19, v3, 4, v19
    s_lshl_b32 s3, s51, 7
    s_lshl_b32 s4, s50, 5
    s_add_u32 s53, s3, s4
    v_add_u32 v19, s53, v19
    v_lshl_add_u32 v4, v19, 10, v18
    v_xor_b32 v5, 64, v4
    v_add_u32 v5, 3072, v5
    v_add_u32 v6, 6144, v4
    v_add_u32 v7, 6144, v5
    s_and_b32 s3, s50, 1
    s_lshl_b32 s3, s3, 4
    s_lshl_b32 s4, s52, 5
    s_add_u32 s3, s3, s4
    v_lshrrev_b32 v19, 3, v1
    v_add_u32 v19, s3, v19
    v_lshl_add_u32 v8, v19, 10, v18
    v_xor_b32 v9, 64, v8
    v_add_u32 v9, 7168, v9
    s_lshl_b32 s54, s50, 12
    s_lshl_b32 s55, s50, 11
    s_add_u32 s55, s55, 16384
    s_waitcnt lgkmcnt(0)
    s_mov_b32 s56, s8
    s_mov_b32 s57, s9
    s_mov_b32 s58, 2097152
    s_mov_b32 s59, 0x00020000
    s_cmp_lt_u32 s50, 2
    s_cselect_b32 s60, s28, s30
    s_cselect_b32 s61, s29, s31
    s_mov_b32 s62, 524288
    s_mov_b32 s63, 0x00020000
    s_bfe_u32 s3, s2, 0x50003
    s_lshl_b32 s3, s3, 14
    s_and_b32 s4, s50, 1
    s_lshl_b32 s4, s4, 13
    s_add_u32 s3, s3, s4
    v_lshl_add_u32 v116, v1, 7, s3
    s_lshl_b32 s3, s52, 6
    v_lshl_add_u32 v20, v2, 1, s3
    global_load_ushort v24, v20, s[24:25]
    global_load_ushort v25, v20, s[26:27]
    global_load_ushort v26, v20, s[36:37]
    s_add_u32 m0, s54, 0
    s_add_u32 s3, s68, 0
    s_and_b32 s3, s3, 1023
    buffer_load_dwordx4 v4, s[56:59], s3 offen offset:0 lds
    buffer_load_dwordx4 v5, s[56:59], s3 offen offset:1024 lds
    buffer_load_dwordx4 v6, s[56:59], s3 offen offset:2048 lds
    buffer_load_dwordx4 v7, s[56:59], s3 offen offset:3072 lds
    s_add_u32 m0, s55, 0
    s_nop 0
    buffer_load_dwordx4 v8, s[60:63], s3 offen offset:0 lds
    buffer_load_dwordx4 v9, s[60:63], s3 offen offset:1024 lds
    s_lshl_b32 s3, s52, 6
    v_lshl_add_u32 v20, v2, 1, s3
    s_lshl_b32 s3, s51, 7
    s_lshl_b32 s4, s52, 3
    s_add_u32 s3, s3, s4
    s_lshl_b32 s4, s50, 1
    s_add_u32 s3, s3, s4
    v_add_u32 v112, s3, v3
    v_lshlrev_b32 v21, 5, v2
    v_lshl_add_u32 v22, v112, 10, v21
    s_lshl_b32 s3, s51, 8
    v_lshl_add_u32 v113, v2, 3, s3
    s_lshl_b32 s3, s52, 12
    s_add_u32 s3, s3, 6356992
    s_add_u32 s64, s46, s3
    s_addc_u32 s65, s47, 0
    s_mov_b32 s66, 4096
    s_mov_b32 s67, 0x00020000
    v_mov_b32 v242, v22
    v_mov_b32 v243, v21
    s_add_u32 m0, s54, 24576
    s_add_u32 s3, s68, 128
    s_and_b32 s3, s3, 1023
    buffer_load_dwordx4 v4, s[56:59], s3 offen offset:0 lds
    buffer_load_dwordx4 v5, s[56:59], s3 offen offset:1024 lds
    buffer_load_dwordx4 v6, s[56:59], s3 offen offset:2048 lds
    buffer_load_dwordx4 v7, s[56:59], s3 offen offset:3072 lds
    s_add_u32 m0, s55, 24576
    s_nop 0
    buffer_load_dwordx4 v8, s[60:63], s3 offen offset:0 lds
    buffer_load_dwordx4 v9, s[60:63], s3 offen offset:1024 lds
    s_add_u32 m0, s54, 49152
    s_add_u32 s3, s68, 256
    s_and_b32 s3, s3, 1023
    buffer_load_dwordx4 v4, s[56:59], s3 offen offset:0 lds
    buffer_load_dwordx4 v5, s[56:59], s3 offen offset:1024 lds
    buffer_load_dwordx4 v6, s[56:59], s3 offen offset:2048 lds
    buffer_load_dwordx4 v7, s[56:59], s3 offen offset:3072 lds
    s_add_u32 m0, s55, 49152
    s_nop 0
    buffer_load_dwordx4 v8, s[60:63], s3 offen offset:0 lds
    buffer_load_dwordx4 v9, s[60:63], s3 offen offset:1024 lds
    v_bfe_u32 v10, v2, 1, 3
    v_xor_b32 v10, v10, v3
    v_lshlrev_b32 v10, 4, v10
    v_lshl_add_u32 v10, v2, 7, v10
    v_add_u32 v10, s54, v10
    v_xor_b32 v11, 32, v10
    v_xor_b32 v12, 64, v10
    v_xor_b32 v13, 96, v10
    v_bfe_u32 v14, v2, 1, 3
    v_xor_b32 v14, v14, v3
    v_lshlrev_b32 v14, 4, v14
    v_lshl_add_u32 v14, v2, 7, v14
    v_add_u32 v14, 16384, v14
    v_xor_b32 v15, 32, v14
    v_xor_b32 v16, 64, v14
    v_xor_b32 v17, 96, v14
    s_bitcmp1_b32 s50, 0
    s_cselect_b64 s[4:5], -1, 0
    s_bitcmp1_b32 s50, 1
    s_cselect_b64 s[6:7], -1, 0
    v_and_b32 v117, 7, v1
    v_lshlrev_b32 v244, 5, v117
    v_lshlrev_b32 v117, 12, v117
    v_lshl_add_u32 v117, v3, 7, v117
    v_add_u32 v117, 6291456, v117
    s_mov_b32 s69, 0
    s_setprio 3
    s_waitcnt vmcnt(12)
    s_barrier
    ds_read_b128 v[64:67], v10 offset:0
    ds_read_b128 v[80:83], v14 offset:0
    ds_read_b128 v[96:99], v14 offset:4096
    ds_read_b128 v[68:71], v11 offset:0
    ds_read_b128 v[84:87], v15 offset:0
    ds_read_b128 v[100:103], v15 offset:4096
    ds_read_b128 v[72:75], v12 offset:0
    ds_read_b128 v[88:91], v16 offset:0
    ds_read_b128 v[104:107], v16 offset:4096
    ds_read_b128 v[76:79], v13 offset:0
    ds_read_b128 v[92:95], v17 offset:0
    ds_read_b128 v[108:111], v17 offset:4096
    s_waitcnt vmcnt(6) lgkmcnt(0)
    s_barrier
    v_mfma_f32_32x32x16_bf16 v[32:47], v[64:67], v[80:83], 0
    ds_read_b128 v[128:131], v10 offset:24576
    ds_read_b128 v[144:147], v14 offset:24576
    s_add_u32 m0, s54, 0
    s_add_u32 s3, s68, 384
    s_and_b32 s3, s3, 1023
    buffer_load_dwordx4 v4, s[56:59], s3 offen offset:0 lds
    v_lshlrev_b32 v24, 16, v24
    v_lshlrev_b32 v25, 16, v25
    v_lshlrev_b32 v26, 16, v26
    v_mfma_f32_32x32x16_bf16 v[48:63], v[64:67], v[96:99], 0
    ds_read_b128 v[160:163], v14 offset:28672
    ds_read_b128 v[132:135], v11 offset:24576
    buffer_load_dwordx4 v5, s[56:59], s3 offen offset:1024 lds
    v_mul_f32 v26, 1069066811, v26
    v_exp_f32 v26, v26
    s_nop 0
    v_cvt_pk_bf16_f32 v26, v26, v26
    v_mfma_f32_32x32x16_bf16 v[32:47], v[68:71], v[84:87], v[32:47]
    ds_read_b128 v[148:151], v15 offset:24576
    ds_read_b128 v[164:167], v15 offset:28672
    buffer_load_dwordx4 v6, s[56:59], s3 offen offset:2048 lds
    v_and_b32 v26, 0xffff0000, v26
    v_mul_f32 v28, v26, v24
    v_mul_f32 v29, v26, v25
    v_mfma_f32_32x32x16_bf16 v[48:63], v[68:71], v[100:103], v[48:63]
    ds_read_b128 v[136:139], v12 offset:24576
    ds_read_b128 v[152:155], v16 offset:24576
    buffer_load_dwordx4 v7, s[56:59], s3 offen offset:3072 lds
    v_mul_f32 v28, 1069066811, v28
    v_mul_f32 v29, 0.15915494, v29
    v_mul_f32 v30, 1.0, v28
    v_mfma_f32_32x32x16_bf16 v[32:47], v[72:75], v[88:91], v[32:47]
    ds_read_b128 v[168:171], v16 offset:28672
    ds_read_b128 v[140:143], v13 offset:24576
    s_add_u32 m0, s55, 0
    s_nop 0
    buffer_load_dwordx4 v8, s[60:63], s3 offen offset:0 lds
    v_mul_f32 v31, 1.0, v29
    v_exp_f32 v30, v30
    v_fract_f32 v31, v31
    v_mfma_f32_32x32x16_bf16 v[48:63], v[72:75], v[104:107], v[48:63]
    ds_read_b128 v[156:159], v17 offset:24576
    ds_read_b128 v[172:175], v17 offset:28672
    buffer_load_dwordx4 v9, s[60:63], s3 offen offset:1024 lds
    v_cos_f32 v20, v31
    v_sin_f32 v21, v31
    v_mul_f32 v20, v20, v30
    v_mfma_f32_32x32x16_bf16 v[32:47], v[76:79], v[92:95], v[32:47]
    v_mul_f32 v21, v21, v30
    v_mul_f32 v26, v24, v24
    v_fmac_f32 v26, v25, v25
    v_mfma_f32_32x32x16_bf16 v[48:63], v[76:79], v[108:111], v[48:63]
    v_rcp_f32 v26, v26
    v_add_f32 v28, -1.0, v20
    v_mov_b32 v29, v21
    s_waitcnt vmcnt(6) lgkmcnt(0)
    s_barrier
    v_mfma_f32_32x32x16_bf16 v[32:47], v[128:131], v[144:147], v[32:47]
    ds_read_b128 v[64:67], v10 offset:49152
    ds_read_b128 v[80:83], v14 offset:49152
    s_add_u32 m0, s54, 24576
    s_add_u32 s3, s68, 512
    s_and_b32 s3, s3, 1023
    buffer_load_dwordx4 v4, s[56:59], s3 offen offset:0 lds
    v_mul_f32 v24, v24, v26
    v_mul_f32 v25, -v25, v26
    v_mul_f32 v30, v29, v25
    v_mfma_f32_32x32x16_bf16 v[48:63], v[128:131], v[160:163], v[48:63]
    ds_read_b128 v[96:99], v14 offset:53248
    ds_read_b128 v[68:71], v11 offset:49152
    buffer_load_dwordx4 v5, s[56:59], s3 offen offset:1024 lds
    v_mul_f32 v31, v28, v25
    v_fma_f32 v23, v29, v24, v31
    v_fma_f32 v22, v28, v24, -v30
    v_mfma_f32_32x32x16_bf16 v[32:47], v[132:135], v[148:151], v[32:47]
    ds_read_b128 v[84:87], v15 offset:49152
    ds_read_b128 v[100:103], v15 offset:53248
    buffer_load_dwordx4 v6, s[56:59], s3 offen offset:2048 lds
    v_mul_f32 v30, v21, v21
    v_mul_f32 v31, v20, v21
    v_fma_f32 v25, v21, v20, v31
    v_mfma_f32_32x32x16_bf16 v[48:63], v[132:135], v[164:167], v[48:63]
    ds_read_b128 v[72:75], v12 offset:49152
    ds_read_b128 v[88:91], v16 offset:49152
    buffer_load_dwordx4 v7, s[56:59], s3 offen offset:3072 lds
    v_fma_f32 v24, v20, v20, -v30
    v_mul_f32 v30, v25, v25
    v_mul_f32 v31, v24, v25
    v_mfma_f32_32x32x16_bf16 v[32:47], v[136:139], v[152:155], v[32:47]
    ds_read_b128 v[104:107], v16 offset:53248
    ds_read_b128 v[76:79], v13 offset:49152
    s_add_u32 m0, s55, 24576
    s_nop 0
    buffer_load_dwordx4 v8, s[60:63], s3 offen offset:0 lds
    v_fma_f32 v25, v25, v24, v31
    v_fma_f32 v24, v24, v24, -v30
    v_mul_f32 v30, v25, v25
    v_mfma_f32_32x32x16_bf16 v[48:63], v[136:139], v[168:171], v[48:63]
    ds_read_b128 v[92:95], v17 offset:49152
    ds_read_b128 v[108:111], v17 offset:53248
    buffer_load_dwordx4 v9, s[60:63], s3 offen offset:1024 lds
    v_mul_f32 v31, v24, v25
    v_fma_f32 v25, v25, v24, v31
    v_fma_f32 v24, v24, v24, -v30
    v_mfma_f32_32x32x16_bf16 v[32:47], v[140:143], v[156:159], v[32:47]
    v_mul_f32 v30, v25, v25
    v_mul_f32 v31, v24, v25
    v_fma_f32 v25, v25, v24, v31
    v_mfma_f32_32x32x16_bf16 v[48:63], v[140:143], v[172:175], v[48:63]
    v_fma_f32 v24, v24, v24, -v30
    v_cmp_eq_u32 vcc, 1, v3
    s_nop 1
    v_cndmask_b32 v30, 1.0, v24, vcc
    s_waitcnt vmcnt(6) lgkmcnt(0)
    s_barrier
    v_mfma_f32_32x32x16_bf16 v[32:47], v[64:67], v[80:83], v[32:47]
    ds_read_b128 v[128:131], v10 offset:0
    ds_read_b128 v[144:147], v14 offset:0
    s_add_u32 m0, s54, 49152
    s_add_u32 s3, s68, 640
    s_and_b32 s3, s3, 1023
    buffer_load_dwordx4 v4, s[56:59], s3 offen offset:0 lds
    v_cndmask_b32 v31, 0, v25, vcc
    v_mul_f32 v18, v25, v25
    v_mul_f32 v19, v24, v25
    v_mfma_f32_32x32x16_bf16 v[48:63], v[64:67], v[96:99], v[48:63]
    ds_read_b128 v[160:163], v14 offset:4096
    ds_read_b128 v[132:135], v11 offset:0
    buffer_load_dwordx4 v5, s[56:59], s3 offen offset:1024 lds
    v_fma_f32 v27, v25, v24, v19
    v_fma_f32 v26, v24, v24, -v18
    v_cndmask_b32 v114, 1.0, v26, s[4:5]
    v_mfma_f32_32x32x16_bf16 v[32:47], v[68:71], v[84:87], v[32:47]
    ds_read_b128 v[148:151], v15 offset:0
    ds_read_b128 v[164:167], v15 offset:4096
    buffer_load_dwordx4 v6, s[56:59], s3 offen offset:2048 lds
    v_cndmask_b32 v115, 0, v27, s[4:5]
    v_mul_f32 v18, v31, v115
    v_mul_f32 v19, v30, v115
    v_mfma_f32_32x32x16_bf16 v[48:63], v[68:71], v[100:103], v[48:63]
    ds_read_b128 v[136:139], v12 offset:0
    ds_read_b128 v[152:155], v16 offset:0
    buffer_load_dwordx4 v7, s[56:59], s3 offen offset:3072 lds
    v_fma_f32 v31, v31, v114, v19
    v_fma_f32 v30, v30, v114, -v18
    v_mul_f32 v18, v27, v27
    v_mfma_f32_32x32x16_bf16 v[32:47], v[72:75], v[88:91], v[32:47]
    ds_read_b128 v[168:171], v16 offset:4096
    ds_read_b128 v[140:143], v13 offset:0
    s_add_u32 m0, s55, 49152
    s_nop 0
    buffer_load_dwordx4 v8, s[60:63], s3 offen offset:0 lds
    v_mul_f32 v19, v26, v27
    v_fma_f32 v27, v27, v26, v19
    v_fma_f32 v26, v26, v26, -v18
    v_mfma_f32_32x32x16_bf16 v[48:63], v[72:75], v[104:107], v[48:63]
    ds_read_b128 v[156:159], v17 offset:0
    ds_read_b128 v[172:175], v17 offset:4096
    buffer_load_dwordx4 v9, s[60:63], s3 offen offset:1024 lds
    v_cndmask_b32 v114, 1.0, v26, s[6:7]
    v_cndmask_b32 v115, 0, v27, s[6:7]
    v_mul_f32 v18, v31, v115
    v_mfma_f32_32x32x16_bf16 v[32:47], v[76:79], v[92:95], v[32:47]
    v_mul_f32 v19, v30, v115
    v_fma_f32 v31, v31, v114, v19
    v_fma_f32 v30, v30, v114, -v18
    v_mfma_f32_32x32x16_bf16 v[48:63], v[76:79], v[108:111], v[48:63]
    v_mul_f32 v18, v27, v27
    v_mul_f32 v19, v26, v27
    v_fma_f32 v27, v27, v26, v19
    s_waitcnt vmcnt(6) lgkmcnt(0)
    s_barrier
    v_mfma_f32_32x32x16_bf16 v[32:47], v[128:131], v[144:147], v[32:47]
    ds_read_b128 v[64:67], v10 offset:24576
    ds_read_b128 v[80:83], v14 offset:24576
    s_add_u32 m0, s54, 0
    s_add_u32 s3, s68, 768
    s_and_b32 s3, s3, 1023
    buffer_load_dwordx4 v4, s[56:59], s3 offen offset:0 lds
    v_fma_f32 v26, v26, v26, -v18
    v_mul_f32 v18, v27, v27
    v_mul_f32 v19, v26, v27
    v_mfma_f32_32x32x16_bf16 v[48:63], v[128:131], v[160:163], v[48:63]
    ds_read_b128 v[96:99], v14 offset:28672
    ds_read_b128 v[68:71], v11 offset:24576
    buffer_load_dwordx4 v5, s[56:59], s3 offen offset:1024 lds
    v_fma_f32 v29, v27, v26, v19
    v_fma_f32 v28, v26, v26, -v18
    v_mul_f32 v18, v29, v29
    v_mfma_f32_32x32x16_bf16 v[32:47], v[132:135], v[148:151], v[32:47]
    ds_read_b128 v[84:87], v15 offset:24576
    ds_read_b128 v[100:103], v15 offset:28672
    buffer_load_dwordx4 v6, s[56:59], s3 offen offset:2048 lds
    v_mul_f32 v19, v28, v29
    v_fma_f32 v29, v29, v28, v19
    v_fma_f32 v28, v28, v28, -v18
    v_mfma_f32_32x32x16_bf16 v[48:63], v[132:135], v[164:167], v[48:63]
    ds_read_b128 v[72:75], v12 offset:24576
    ds_read_b128 v[88:91], v16 offset:24576
    buffer_load_dwordx4 v7, s[56:59], s3 offen offset:3072 lds
    v_mul_f32 v18, v29, v29
    v_mul_f32 v19, v28, v29
    v_fma_f32 v29, v29, v28, v19
    v_mfma_f32_32x32x16_bf16 v[32:47], v[136:139], v[152:155], v[32:47]
    ds_read_b128 v[104:107], v16 offset:28672
    ds_read_b128 v[76:79], v13 offset:24576
    s_add_u32 m0, s55, 0
    s_nop 0
    buffer_load_dwordx4 v8, s[60:63], s3 offen offset:0 lds
    v_fma_f32 v28, v28, v28, -v18
    v_mfma_f32_32x32x16_bf16 v[48:63], v[136:139], v[168:171], v[48:63]
    ds_read_b128 v[92:95], v17 offset:24576
    ds_read_b128 v[108:111], v17 offset:28672
    buffer_load_dwordx4 v9, s[60:63], s3 offen offset:1024 lds
    v_mfma_f32_32x32x16_bf16 v[32:47], v[140:143], v[156:159], v[32:47]
    v_mfma_f32_32x32x16_bf16 v[48:63], v[140:143], v[172:175], v[48:63]
    s_waitcnt vmcnt(6) lgkmcnt(0)
    s_barrier
    v_mfma_f32_32x32x16_bf16 v[32:47], v[64:67], v[80:83], v[32:47]
    ds_read_b128 v[128:131], v10 offset:49152
    ds_read_b128 v[144:147], v14 offset:49152
    s_add_u32 m0, s54, 24576
    s_add_u32 s3, s68, 896
    s_and_b32 s3, s3, 1023
    buffer_load_dwordx4 v4, s[56:59], s3 offen offset:0 lds
    v_mfma_f32_32x32x16_bf16 v[48:63], v[64:67], v[96:99], v[48:63]
    ds_read_b128 v[160:163], v14 offset:53248
    ds_read_b128 v[132:135], v11 offset:49152
    buffer_load_dwordx4 v5, s[56:59], s3 offen offset:1024 lds
    v_mfma_f32_32x32x16_bf16 v[32:47], v[68:71], v[84:87], v[32:47]
    ds_read_b128 v[148:151], v15 offset:49152
    ds_read_b128 v[164:167], v15 offset:53248
    buffer_load_dwordx4 v6, s[56:59], s3 offen offset:2048 lds
    v_mfma_f32_32x32x16_bf16 v[48:63], v[68:71], v[100:103], v[48:63]
    ds_read_b128 v[136:139], v12 offset:49152
    ds_read_b128 v[152:155], v16 offset:49152
    buffer_load_dwordx4 v7, s[56:59], s3 offen offset:3072 lds
    v_mfma_f32_32x32x16_bf16 v[32:47], v[72:75], v[88:91], v[32:47]
    ds_read_b128 v[168:171], v16 offset:53248
    ds_read_b128 v[140:143], v13 offset:49152
    s_add_u32 m0, s55, 24576
    s_nop 0
    buffer_load_dwordx4 v8, s[60:63], s3 offen offset:0 lds
    v_mfma_f32_32x32x16_bf16 v[48:63], v[72:75], v[104:107], v[48:63]
    ds_read_b128 v[156:159], v17 offset:49152
    ds_read_b128 v[172:175], v17 offset:53248
    buffer_load_dwordx4 v9, s[60:63], s3 offen offset:1024 lds
    v_mfma_f32_32x32x16_bf16 v[32:47], v[76:79], v[92:95], v[32:47]
    s_cmp_lg_u32 s50, 0
    s_cbranch_scc1 L_g40
    global_load_dword v119, v244, s[44:45] sc1
L_g40:
    v_mfma_f32_32x32x16_bf16 v[48:63], v[76:79], v[108:111], v[48:63]
    s_waitcnt vmcnt(6) lgkmcnt(0)
    s_barrier
    v_mfma_f32_32x32x16_bf16 v[32:47], v[128:131], v[144:147], v[32:47]
    ds_read_b128 v[64:67], v10 offset:0
    ds_read_b128 v[80:83], v14 offset:0
    s_cmp_lt_u32 s50, 2
    s_cselect_b32 s60, s32, s34
    s_cselect_b32 s61, s33, s35
    buffer_load_dword v114, v116, s[60:63], 0 offen
    v_mfma_f32_32x32x16_bf16 v[48:63], v[128:131], v[160:163], v[48:63]
    ds_read_b128 v[96:99], v14 offset:4096
    ds_read_b128 v[68:71], v11 offset:0
    global_load_dwordx4 v[232:235], v242, s[8:9]
    v_mfma_f32_32x32x16_bf16 v[32:47], v[132:135], v[148:151], v[32:47]
    ds_read_b128 v[84:87], v15 offset:0
    ds_read_b128 v[100:103], v15 offset:4096
    global_load_dwordx4 v[236:239], v242, s[8:9] offset:16
    v_mfma_f32_32x32x16_bf16 v[48:63], v[132:135], v[164:167], v[48:63]
    ds_read_b128 v[72:75], v12 offset:0
    ds_read_b128 v[88:91], v16 offset:0
    global_load_dwordx4 v[248:251], v243, s[40:41]
    v_mfma_f32_32x32x16_bf16 v[32:47], v[136:139], v[152:155], v[32:47]
    ds_read_b128 v[104:107], v16 offset:4096
    ds_read_b128 v[76:79], v13 offset:0
    global_load_dwordx4 v[252:255], v243, s[40:41] offset:16
    v_mfma_f32_32x32x16_bf16 v[48:63], v[136:139], v[168:171], v[48:63]
    ds_read_b128 v[92:95], v17 offset:0
    ds_read_b128 v[108:111], v17 offset:4096
    v_mfma_f32_32x32x16_bf16 v[32:47], v[140:143], v[156:159], v[32:47]
    v_mfma_f32_32x32x16_bf16 v[48:63], v[140:143], v[172:175], v[48:63]
    s_waitcnt vmcnt(5) lgkmcnt(0)
    s_barrier
    v_mfma_f32_32x32x16_bf16 v[32:47], v[64:67], v[80:83], v[32:47]
    ds_read_b128 v[128:131], v10 offset:24576
    ds_read_b128 v[144:147], v14 offset:24576
    s_cmp_lg_u32 s50, 0
    s_cbranch_scc1 L_g20
L_g41:
    v_cmp_ne_u32 vcc, 1, v119
    s_add_u32 s69, s69, 1
    s_cmp_lt_u32 s69, 0x400000
    s_cbranch_vccz L_g42
    global_load_dword v119, v244, s[44:45] sc1
    s_waitcnt vmcnt(0)
    s_cbranch_scc1 L_g41
L_g42:
    global_load_dword v119, v117, s[46:47] sc1
L_g20:
    v_mfma_f32_32x32x16_bf16 v[48:63], v[64:67], v[96:99], v[48:63]
    ds_read_b128 v[160:163], v14 offset:28672
    ds_read_b128 v[132:135], v11 offset:24576
    s_and_b32 s62, s50, 1
    s_lshr_b32 s63, s50, 1
    s_and_b32 s3, s52, 7
    s_lshl_b32 s3, s3, 6
    v_mfma_f32_32x32x16_bf16 v[32:47], v[68:71], v[84:87], v[32:47]
    ds_read_b128 v[148:151], v15 offset:24576
    ds_read_b128 v[164:167], v15 offset:28672
    s_lshl_b32 s4, s63, 5
    s_add_u32 s48, s3, s4
    s_lshr_b32 s3, s52, 3
    s_lshl_b32 s3, s3, 6
    v_mfma_f32_32x32x16_bf16 v[48:63], v[68:71], v[100:103], v[48:63]
    ds_read_b128 v[136:139], v12 offset:24576
    ds_read_b128 v[152:155], v16 offset:24576
    s_lshl_b32 s4, s51, 7
    s_add_u32 s49, s3, s4
    v_and_b32 v18, 7, v1
    v_lshrrev_b32 v19, 4, v1
    v_mfma_f32_32x32x16_bf16 v[32:47], v[72:75], v[88:91], v[32:47]
    ds_read_b128 v[168:171], v16 offset:28672
    ds_read_b128 v[140:143], v13 offset:24576
    v_xor_b32 v18, v18, v19
    v_lshlrev_b32 v118, 4, v18
    v_lshrrev_b32 v19, 3, v1
    v_add_u32 v19, s48, v19
    v_mfma_f32_32x32x16_bf16 v[48:63], v[72:75], v[104:107], v[48:63]
    ds_read_b128 v[156:159], v17 offset:24576
    ds_read_b128 v[172:175], v17 offset:28672
    v_lshl_add_u32 v4, v19, 10, v118
    s_lshl_b32 s3, s62, 9
    v_add_u32 v4, s3, v4
    v_xor_b32 v5, 64, v4
    v_mfma_f32_32x32x16_bf16 v[32:47], v[76:79], v[92:95], v[32:47]
    v_add_u32 v5, 7168, v5
    v_add_u32 v6, 14336, v4
    v_add_u32 v7, 14336, v5
    s_lshl_b32 s54, s50, 14
    v_mfma_f32_32x32x16_bf16 v[48:63], v[76:79], v[108:111], v[48:63]
    s_waitcnt lgkmcnt(0)
    v_mfma_f32_32x32x16_bf16 v[32:47], v[128:131], v[144:147], v[32:47]
    v_mfma_f32_32x32x16_bf16 v[48:63], v[128:131], v[160:163], v[48:63]
    v_mfma_f32_32x32x16_bf16 v[32:47], v[132:135], v[148:151], v[32:47]
    v_mfma_f32_32x32x16_bf16 v[48:63], v[132:135], v[164:167], v[48:63]
    v_mfma_f32_32x32x16_bf16 v[32:47], v[136:139], v[152:155], v[32:47]
    v_mfma_f32_32x32x16_bf16 v[48:63], v[136:139], v[168:171], v[48:63]
    v_mfma_f32_32x32x16_bf16 v[32:47], v[140:143], v[156:159], v[32:47]
    v_mfma_f32_32x32x16_bf16 v[48:63], v[140:143], v[172:175], v[48:63]
    s_lshl_b32 s3, s50, 9
    s_add_u32 s3, s3, 73728
    v_lshl_add_u32 v125, v1, 3, s3
    v_lshlrev_b32 v126, 3, v2
    v_add_u32 v126, 73728, v126
    s_lshl_b32 s3, s50, 1
    v_add_u32 v127, s3, v3
    s_nop 3
    v_fma_f32 v64, v20, v32, v33
    v_fma_f32 v65, v20, v48, v49
    v_fma_f32 v64, -v21, v48, v64
    v_fma_f32 v65, v21, v32, v65
    v_fma_f32 v66, v20, v64, v34
    v_fma_f32 v67, v20, v65, v50
    v_fma_f32 v66, -v21, v65, v66
    v_fma_f32 v67, v21, v64, v67
    v_fma_f32 v64, v20, v66, v35
    v_fma_f32 v65, v20, v67, v51
    v_fma_f32 v64, -v21, v67, v64
    v_fma_f32 v65, v21, v66, v65
    v_fma_f32 v66, v20, v64, v36
    v_fma_f32 v67, v20, v65, v52
    v_fma_f32 v66, -v21, v65, v66
    v_fma_f32 v67, v21, v64, v67
    v_fma_f32 v64, v20, v66, v37
    v_fma_f32 v65, v20, v67, v53
    v_fma_f32 v64, -v21, v67, v64
    v_fma_f32 v65, v21, v66, v65
    v_fma_f32 v66, v20, v64, v38
    v_fma_f32 v67, v20, v65, v54
    v_fma_f32 v66, -v21, v65, v66
    v_fma_f32 v67, v21, v64, v67
    v_fma_f32 v64, v20, v66, v39
    v_fma_f32 v65, v20, v67, v55
    v_fma_f32 v64, -v21, v67, v64
    v_fma_f32 v65, v21, v66, v65
    v_fma_f32 v66, v20, v64, v40
    v_fma_f32 v67, v20, v65, v56
    v_fma_f32 v66, -v21, v65, v66
    v_fma_f32 v67, v21, v64, v67
    v_fma_f32 v64, v20, v66, v41
    v_fma_f32 v65, v20, v67, v57
    v_fma_f32 v64, -v21, v67, v64
    v_fma_f32 v65, v21, v66, v65
    v_fma_f32 v66, v20, v64, v42
    v_fma_f32 v67, v20, v65, v58
    v_fma_f32 v66, -v21, v65, v66
    v_fma_f32 v67, v21, v64, v67
    v_fma_f32 v64, v20, v66, v43
    v_fma_f32 v65, v20, v67, v59
    v_fma_f32 v64, -v21, v67, v64
    v_fma_f32 v65, v21, v66, v65
    v_fma_f32 v66, v20, v64, v44
    v_fma_f32 v67, v20, v65, v60
    v_fma_f32 v66, -v21, v65, v66
    v_fma_f32 v67, v21, v64, v67
    v_fma_f32 v64, v20, v66, v45
    v_fma_f32 v65, v20, v67, v61
    v_fma_f32 v64, -v21, v67, v64
    v_fma_f32 v65, v21, v66, v65
    v_fma_f32 v66, v20, v64, v46
    v_fma_f32 v67, v20, v65, v62
    v_fma_f32 v66, -v21, v65, v66
    v_fma_f32 v67, v21, v64, v67
    v_fma_f32 v64, v20, v66, v47
    v_fma_f32 v65, v20, v67, v63
    v_fma_f32 v64, -v21, v67, v64
    v_fma_f32 v65, v21, v66, v65
    ds_write_b64 v125, v[64:65]
    s_mov_b32 s69, 0
    s_cmp_lg_u32 s50, 0
    s_cbranch_scc1 L_g5
    s_waitcnt vmcnt(0)
L_g4:
    v_cmp_eq_u32 vcc, 0, v119
    s_nop 1
    s_cbranch_vccz L_g5
    s_sleep 2
    global_load_dword v119, v117, s[46:47] sc1
    s_waitcnt vmcnt(0)
    s_add_u32 s69, s69, 1
    s_cmp_lt_u32 s69, 0x400000
    s_cbranch_scc1 L_g4
L_g5:
    s_waitcnt lgkmcnt(0)
    s_barrier
    ds_read_b64 v[64:65], v126 offset:0
    ds_read_b64 v[66:67], v126 offset:256
    ds_read_b64 v[68:69], v126 offset:512
    ds_read_b64 v[70:71], v126 offset:768
    ds_read_b64 v[72:73], v126 offset:1024
    ds_read_b64 v[74:75], v126 offset:1280
    ds_read_b64 v[76:77], v126 offset:1536
    ds_read_b64 v[78:79], v126 offset:1792
    v_mov_b32 v80, 0
    v_mov_b32 v81, 0
    s_waitcnt lgkmcnt(0)
    v_fma_f32 v18, -v65, v25, v66
    v_fma_f32 v19, v64, v25, v67
    v_fma_f32 v67, v65, v24, v19
    v_fma_f32 v66, v64, v24, v18
    v_fma_f32 v18, -v67, v25, v68
    v_fma_f32 v19, v66, v25, v69
    v_fma_f32 v69, v67, v24, v19
    v_fma_f32 v68, v66, v24, v18
    v_fma_f32 v18, -v69, v25, v70
    v_fma_f32 v19, v68, v25, v71
    v_fma_f32 v71, v69, v24, v19
    v_fma_f32 v70, v68, v24, v18
    v_fma_f32 v18, -v71, v25, v72
    v_fma_f32 v19, v70, v25, v73
    v_fma_f32 v73, v71, v24, v19
    v_fma_f32 v72, v70, v24, v18
    v_fma_f32 v18, -v73, v25, v74
    v_fma_f32 v19, v72, v25, v75
    v_fma_f32 v75, v73, v24, v19
    v_fma_f32 v74, v72, v24, v18
    v_fma_f32 v18, -v75, v25, v76
    v_fma_f32 v19, v74, v25, v77
    v_fma_f32 v77, v75, v24, v19
    v_fma_f32 v76, v74, v24, v18
    v_fma_f32 v18, -v77, v25, v78
    v_fma_f32 v19, v76, v25, v79
    v_fma_f32 v79, v77, v24, v19
    v_fma_f32 v78, v76, v24, v18
    v_mov_b32 v18, 0x7fc00000
    v_cmp_eq_u32 vcc, -1, v78
    s_nop 1
    v_cndmask_b32 v78, v78, v18, vcc
    v_cmp_eq_u32 vcc, -1, v79
    s_nop 1
    v_cndmask_b32 v79, v79, v18, vcc
    v_lshlrev_b32 v82, 11, v3
    v_sub_u32 v82, v113, v82
    s_cmp_lg_u32 s50, 0
    s_cbranch_scc1 L_g3
    buffer_store_dwordx2 v[78:79], v113, s[64:67], 0 offen sc1
    v_subrev_u32 v104, 256, v82
    v_subrev_u32 v105, 512, v82
    v_subrev_u32 v106, 768, v82
    v_subrev_u32 v107, 1024, v82
    v_subrev_u32 v108, 1280, v82
    v_subrev_u32 v109, 1536, v82
    v_subrev_u32 v110, 1792, v82
    v_subrev_u32 v111, 2048, v82
    buffer_load_dwordx2 v[84:85], v104, s[64:67], 0 offen sc1
    buffer_load_dwordx2 v[86:87], v105, s[64:67], 0 offen sc1
    buffer_load_dwordx2 v[88:89], v106, s[64:67], 0 offen sc1
    buffer_load_dwordx2 v[90:91], v107, s[64:67], 0 offen sc1
    buffer_load_dwordx2 v[92:93], v108, s[64:67], 0 offen sc1
    buffer_load_dwordx2 v[94:95], v109, s[64:67], 0 offen sc1
    buffer_load_dwordx2 v[96:97], v110, s[64:67], 0 offen sc1
    buffer_load_dwordx2 v[98:99], v111, s[64:67], 0 offen sc1
L_g3:
    v_cmp_eq_u32 vcc, 1, v127
    s_nop 1
    v_cndmask_b32 v80, v80, v64, vcc
    v_cndmask_b32 v81, v81, v65, vcc
    v_cmp_eq_u32 vcc, 2, v127
    s_nop 1
    v_cndmask_b32 v80, v80, v66, vcc
    v_cndmask_b32 v81, v81, v67, vcc
    v_cmp_eq_u32 vcc, 3, v127
    s_nop 1
    v_cndmask_b32 v80, v80, v68, vcc
    v_cndmask_b32 v81, v81, v69, vcc
    v_cmp_eq_u32 vcc, 4, v127
    s_nop 1
    v_cndmask_b32 v80, v80, v70, vcc
    v_cndmask_b32 v81, v81, v71, vcc
    v_cmp_eq_u32 vcc, 5, v127
    s_nop 1
    v_cndmask_b32 v80, v80, v72, vcc
    v_cndmask_b32 v81, v81, v73, vcc
    v_cmp_eq_u32 vcc, 6, v127
    s_nop 1
    v_cndmask_b32 v80, v80, v74, vcc
    v_cndmask_b32 v81, v81, v75, vcc
    v_cmp_eq_u32 vcc, 7, v127
    s_nop 1
    v_cndmask_b32 v80, v80, v76, vcc
    v_cndmask_b32 v81, v81, v77, vcc
    v_bfe_u32 v10, v2, 1, 3
    v_xor_b32 v10, v10, v3
    v_lshlrev_b32 v10, 4, v10
    v_lshl_add_u32 v10, v2, 7, v10
    v_add_u32 v10, s54, v10
    v_xor_b32 v11, 32, v10
    v_xor_b32 v12, 64, v10
    v_xor_b32 v13, 96, v10
    s_cmp_eq_u32 s50, 0
    s_cbranch_scc1 L_g30
    s_waitcnt vmcnt(0)
    v_mov_b32 v120, 0
    v_lshlrev_b32 v121, 16, v232
    v_lshlrev_b32 v122, 16, v248
    v_and_b32 v123, 0xffff0000, v232
    v_and_b32 v124, 0xffff0000, v248
    v_mul_f32 v121, v121, v122
    v_mul_f32 v123, v123, v124
    v_cvt_pk_bf16_f32 v121, v121, v123
    v_lshlrev_b32 v122, 16, v121
    v_and_b32 v123, 0xffff0000, v121
    v_add_f32 v120, v120, v122
    v_add_f32 v120, v120, v123
    v_lshlrev_b32 v121, 16, v233
    v_lshlrev_b32 v122, 16, v249
    v_and_b32 v123, 0xffff0000, v233
    v_and_b32 v124, 0xffff0000, v249
    v_mul_f32 v121, v121, v122
    v_mul_f32 v123, v123, v124
    v_cvt_pk_bf16_f32 v121, v121, v123
    v_lshlrev_b32 v122, 16, v121
    v_and_b32 v123, 0xffff0000, v121
    v_add_f32 v120, v120, v122
    v_add_f32 v120, v120, v123
    v_lshlrev_b32 v121, 16, v234
    v_lshlrev_b32 v122, 16, v250
    v_and_b32 v123, 0xffff0000, v234
    v_and_b32 v124, 0xffff0000, v250
    v_mul_f32 v121, v121, v122
    v_mul_f32 v123, v123, v124
    v_cvt_pk_bf16_f32 v121, v121, v123
    v_lshlrev_b32 v122, 16, v121
    v_and_b32 v123, 0xffff0000, v121
    v_add_f32 v120, v120, v122
    v_add_f32 v120, v120, v123
    v_lshlrev_b32 v121, 16, v235
    v_lshlrev_b32 v122, 16, v251
    v_and_b32 v123, 0xffff0000, v235
    v_and_b32 v124, 0xffff0000, v251
    v_mul_f32 v121, v121, v122
    v_mul_f32 v123, v123, v124
    v_cvt_pk_bf16_f32 v121, v121, v123
    v_lshlrev_b32 v122, 16, v121
    v_and_b32 v123, 0xffff0000, v121
    v_add_f32 v120, v120, v122
    v_add_f32 v120, v120, v123
    v_lshlrev_b32 v121, 16, v236
    v_lshlrev_b32 v122, 16, v252
    v_and_b32 v123, 0xffff0000, v236
    v_and_b32 v124, 0xffff0000, v252
    v_mul_f32 v121, v121, v122
    v_mul_f32 v123, v123, v124
    v_cvt_pk_bf16_f32 v121, v121, v123
    v_lshlrev_b32 v122, 16, v121
    v_and_b32 v123, 0xffff0000, v121
    v_add_f32 v120, v120, v122
    v_add_f32 v120, v120, v123
    v_lshlrev_b32 v121, 16, v237
    v_lshlrev_b32 v122, 16, v253
    v_and_b32 v123, 0xffff0000, v237
    v_and_b32 v124, 0xffff0000, v253
    v_mul_f32 v121, v121, v122
    v_mul_f32 v123, v123, v124
    v_cvt_pk_bf16_f32 v121, v121, v123
    v_lshlrev_b32 v122, 16, v121
    v_and_b32 v123, 0xffff0000, v121
    v_add_f32 v120, v120, v122
    v_add_f32 v120, v120, v123
    v_lshlrev_b32 v121, 16, v238
    v_lshlrev_b32 v122, 16, v254
    v_and_b32 v123, 0xffff0000, v238
    v_and_b32 v124, 0xffff0000, v254
    v_mul_f32 v121, v121, v122
    v_mul_f32 v123, v123, v124
    v_cvt_pk_bf16_f32 v121, v121, v123
    v_lshlrev_b32 v122, 16, v121
    v_and_b32 v123, 0xffff0000, v121
    v_add_f32 v120, v120, v122
    v_add_f32 v120, v120, v123
    v_lshlrev_b32 v121, 16, v239
    v_lshlrev_b32 v122, 16, v255
    v_and_b32 v123, 0xffff0000, v239
    v_and_b32 v124, 0xffff0000, v255
    v_mul_f32 v121, v121, v122
    v_mul_f32 v123, v123, v124
    v_cvt_pk_bf16_f32 v121, v121, v123
    v_lshlrev_b32 v122, 16, v121
    v_and_b32 v123, 0xffff0000, v121
    v_add_f32 v120, v120, v122
    v_add_f32 v120, v120, v123
    ds_swizzle_b32 v121, v120 offset:1055
    s_waitcnt lgkmcnt(0)
    v_add_f32 v120, v120, v121
    ds_swizzle_b32 v121, v120 offset:2079
    s_waitcnt lgkmcnt(0)
    v_add_f32 v120, v120, v121
    ds_swizzle_b32 v121, v120 offset:4127
    s_waitcnt lgkmcnt(0)
    v_add_f32 v120, v120, v121
    ds_swizzle_b32 v121, v120 offset:8223
    s_waitcnt lgkmcnt(0)
    v_add_f32 v120, v120, v121
    ds_swizzle_b32 v121, v120 offset:16415
    s_waitcnt lgkmcnt(0)
    v_add_f32 v120, v120, v121
    v_cvt_pk_bf16_f32 v120, v120, v120
    v_and_b32 v120, 0xffff0000, v120
    v_mul_f32 v120, 3216550459, v120
    v_exp_f32 v120, v120
    s_nop 0
    v_add_f32 v120, 1.0, v120
    v_rcp_f32 v116, v120
    s_nop 0
    v_cvt_pk_bf16_f32 v116, v116, v116
    v_and_b32 v116, 0xffff0000, v116
    s_lshl_b32 s3, s50, 3
    s_add_u32 s3, s3, 75776
    v_lshl_add_u32 v112, v3, 2, s3
    ds_write_b32 v112, v116
L_g30:
    v_mul_f32 v18, v23, v48
    v_mul_f32 v19, v23, v32
    v_fma_f32 v32, v22, v32, -v18
    v_fma_f32 v48, v22, v48, v19
    v_mul_f32 v18, v23, v49
    v_mul_f32 v19, v23, v33
    v_fma_f32 v33, v22, v33, -v18
    v_fma_f32 v49, v22, v49, v19
    v_mul_f32 v18, v23, v50
    v_mul_f32 v19, v23, v34
    v_fma_f32 v34, v22, v34, -v18
    v_fma_f32 v50, v22, v50, v19
    v_mul_f32 v18, v23, v51
    v_mul_f32 v19, v23, v35
    v_fma_f32 v35, v22, v35, -v18
    v_fma_f32 v51, v22, v51, v19
    v_mul_f32 v18, v23, v52
    v_mul_f32 v19, v23, v36
    v_fma_f32 v36, v22, v36, -v18
    v_fma_f32 v52, v22, v52, v19
    v_mul_f32 v18, v23, v53
    v_mul_f32 v19, v23, v37
    v_fma_f32 v37, v22, v37, -v18
    v_fma_f32 v53, v22, v53, v19
    v_mul_f32 v18, v23, v54
    v_mul_f32 v19, v23, v38
    v_fma_f32 v38, v22, v38, -v18
    v_fma_f32 v54, v22, v54, v19
    v_mul_f32 v18, v23, v55
    v_mul_f32 v19, v23, v39
    v_fma_f32 v39, v22, v39, -v18
    v_fma_f32 v55, v22, v55, v19
    v_mul_f32 v18, v23, v56
    v_mul_f32 v19, v23, v40
    v_fma_f32 v40, v22, v40, -v18
    v_fma_f32 v56, v22, v56, v19
    v_mul_f32 v18, v23, v57
    v_mul_f32 v19, v23, v41
    v_fma_f32 v41, v22, v41, -v18
    v_fma_f32 v57, v22, v57, v19
    v_mul_f32 v18, v23, v58
    v_mul_f32 v19, v23, v42
    v_fma_f32 v42, v22, v42, -v18
    v_fma_f32 v58, v22, v58, v19
    v_mul_f32 v18, v23, v59
    v_mul_f32 v19, v23, v43
    v_fma_f32 v43, v22, v43, -v18
    v_fma_f32 v59, v22, v59, v19
    v_mul_f32 v18, v23, v60
    v_mul_f32 v19, v23, v44
    v_fma_f32 v44, v22, v44, -v18
    v_fma_f32 v60, v22, v60, v19
    v_mul_f32 v18, v23, v61
    v_mul_f32 v19, v23, v45
    v_fma_f32 v45, v22, v45, -v18
    v_fma_f32 v61, v22, v61, v19
    v_mul_f32 v18, v23, v62
    v_mul_f32 v19, v23, v46
    v_fma_f32 v46, v22, v46, -v18
    v_fma_f32 v62, v22, v62, v19
    v_mul_f32 v18, v23, v63
    v_mul_f32 v19, v23, v47
    v_fma_f32 v47, v22, v47, -v18
    v_fma_f32 v63, v22, v63, v19
    v_and_b32 v8, 1, v1
    v_cmp_eq_u32 vcc, 1, v8
    v_mov_b32 v9, 0x05040100
    v_mov_b32 v14, 0x03020706
    v_cndmask_b32 v9, v9, v14, vcc
    v_lshlrev_b32 v8, 6, v8
    v_lshrrev_b32 v14, 1, v2
    v_lshl_add_u32 v8, v14, 2, v8
    v_lshl_add_u32 v8, v3, 10, v8
    s_lshl_b32 s3, s50, 11
    s_add_u32 s3, s3, 65536
    v_add_u32 v8, s3, v8
    v_lshl_add_u32 v14, v1, 4, s3
    s_lshl_b32 s3, s51, 18
    s_lshl_b32 s4, s63, 17
    s_add_u32 s3, s3, s4
    s_lshl_b32 s4, s52, 13
    s_add_u32 s3, s3, s4
    s_lshl_b32 s4, s62, 12
    s_add_u32 s3, s3, s4
    s_add_u32 s3, s3, 12582912
    v_lshlrev_b32 v15, 4, v1
    v_add_u32 v15, s3, v15
    s_lshl_b32 s3, s62, 5
    s_add_u32 s3, s3, s49
    v_lshl_add_u32 v120, v3, 4, s3
    v_add_u32 v121, s48, v2
    v_lshlrev_b32 v122, 1, v121
    v_lshlrev_b32 v16, 12, v121
    v_lshl_add_u32 v16, v120, 1, v16
    v_add_u32 v16, 4194304, v16
    v_and_b32 v17, 127, v120
    v_lshlrev_b32 v17, 2, v17
    v_add_u32 v17, 76160, v17
    v_lshl_add_u32 v123, v120, 10, v122
    v_lshlrev_b32 v83, 1, v123
    v_add_u32 v123, 4096, v123
    v_add_u32 v124, 8192, v123
    s_mov_b32 s56, s32
    s_mov_b32 s57, s33
    s_mov_b32 s58, 524288
    s_mov_b32 s59, 0x00020000
    s_cmp_eq_u32 s50, 0
    s_cbranch_scc1 L_g6
    s_add_u32 m0, s54, 0
    s_movk_i32 s61, 0
    buffer_load_dwordx4 v4, s[56:59], s61 offen offset:0 lds
    buffer_load_dwordx4 v5, s[56:59], s61 offen offset:1024 lds
    buffer_load_dwordx4 v6, s[56:59], s61 offen offset:2048 lds
    buffer_load_dwordx4 v7, s[56:59], s61 offen offset:3072 lds
    s_add_u32 m0, s54, 4096
    s_movk_i32 s61, 128
    buffer_load_dwordx4 v4, s[56:59], s61 offen offset:0 lds
    buffer_load_dwordx4 v5, s[56:59], s61 offen offset:1024 lds
    buffer_load_dwordx4 v6, s[56:59], s61 offen offset:2048 lds
    buffer_load_dwordx4 v7, s[56:59], s61 offen offset:3072 lds
    s_add_u32 m0, s54, 8192
    s_movk_i32 s61, 256
    buffer_load_dwordx4 v4, s[56:59], s61 offen offset:0 lds
    buffer_load_dwordx4 v5, s[56:59], s61 offen offset:1024 lds
    buffer_load_dwordx4 v6, s[56:59], s61 offen offset:2048 lds
    buffer_load_dwordx4 v7, s[56:59], s61 offen offset:3072 lds
    s_add_u32 m0, s54, 12288
    s_movk_i32 s61, 384
    buffer_load_dwordx4 v4, s[56:59], s61 offen offset:0 lds
    buffer_load_dwordx4 v5, s[56:59], s61 offen offset:1024 lds
    buffer_load_dwordx4 v6, s[56:59], s61 offen offset:2048 lds
    buffer_load_dwordx4 v7, s[56:59], s61 offen offset:3072 lds
    s_branch L_g21
L_g6:
    s_waitcnt vmcnt(0)
    v_max_u32 v18, v84, v85
    v_max3_u32 v18, v18, v86, v87
    v_max3_u32 v18, v18, v88, v89
    v_max3_u32 v18, v18, v90, v91
    v_max3_u32 v18, v18, v92, v93
    v_max3_u32 v18, v18, v94, v95
    v_max3_u32 v18, v18, v96, v97
    v_max3_u32 v18, v18, v98, v99
    v_cmp_eq_u32 vcc, -1, v18
    s_nop 1
    s_cbranch_vccz L_g7
    s_sleep 1
    buffer_load_dwordx2 v[84:85], v104, s[64:67], 0 offen sc1
    buffer_load_dwordx2 v[86:87], v105, s[64:67], 0 offen sc1
    buffer_load_dwordx2 v[88:89], v106, s[64:67], 0 offen sc1
    buffer_load_dwordx2 v[90:91], v107, s[64:67], 0 offen sc1
    buffer_load_dwordx2 v[92:93], v108, s[64:67], 0 offen sc1
    buffer_load_dwordx2 v[94:95], v109, s[64:67], 0 offen sc1
    buffer_load_dwordx2 v[96:97], v110, s[64:67], 0 offen sc1
    buffer_load_dwordx2 v[98:99], v111, s[64:67], 0 offen sc1
    s_add_u32 s69, s69, 1
    s_cmp_lt_u32 s69, 0x400000
    s_cbranch_scc1 L_g6
    s_waitcnt vmcnt(0)
L_g7:
    v_fma_f32 v18, -v99, v27, v96
    v_fma_f32 v19, v98, v27, v97
    v_fma_f32 v97, v99, v26, v19
    v_fma_f32 v96, v98, v26, v18
    v_fma_f32 v18, -v97, v27, v94
    v_fma_f32 v19, v96, v27, v95
    v_fma_f32 v95, v97, v26, v19
    v_fma_f32 v94, v96, v26, v18
    v_fma_f32 v18, -v95, v27, v92
    v_fma_f32 v19, v94, v27, v93
    v_fma_f32 v93, v95, v26, v19
    v_fma_f32 v92, v94, v26, v18
    v_fma_f32 v18, -v93, v27, v90
    v_fma_f32 v19, v92, v27, v91
    v_fma_f32 v91, v93, v26, v19
    v_fma_f32 v90, v92, v26, v18
    v_fma_f32 v18, -v91, v27, v88
    v_fma_f32 v19, v90, v27, v89
    v_fma_f32 v89, v91, v26, v19
    v_fma_f32 v88, v90, v26, v18
    v_fma_f32 v18, -v89, v27, v86
    v_fma_f32 v19, v88, v27, v87
    v_fma_f32 v87, v89, v26, v19
    v_fma_f32 v86, v88, v26, v18
    v_fma_f32 v18, -v87, v27, v84
    v_fma_f32 v19, v86, v27, v85
    v_fma_f32 v85, v87, v26, v19
    v_fma_f32 v84, v86, v26, v18
    v_mov_b32 v86, v84
    v_mov_b32 v87, v85
    s_nop 0
    v_permlane32_swap_b32 v84, v86
    v_permlane32_swap_b32 v85, v87
    v_fma_f32 v18, -v87, v29, v84
    v_fma_f32 v19, v86, v29, v85
    v_fma_f32 v85, v87, v28, v19
    v_fma_f32 v84, v86, v28, v18
    ds_write_b64 v126, v[84:85] offset:2112
L_g21:
    s_waitcnt lgkmcnt(0)
    s_barrier
    ds_read_b64 v[84:85], v126 offset:2112
    s_mov_b32 s56, s46
    s_mov_b32 s57, s47
    s_mov_b32 s58, 16777216
    s_mov_b32 s59, 0x00020000
    s_waitcnt lgkmcnt(0)
    v_fma_f32 v18, -v85, v31, v80
    v_fma_f32 v19, v84, v31, v81
    v_fma_f32 v85, v85, v30, v19
    v_fma_f32 v84, v84, v30, v18
    v_mul_f32 v18, v85, v23
    v_mul_f32 v19, v84, v23
    v_fma_f32 v85, v85, v22, v19
    v_fma_f32 v84, v84, v22, -v18
    v_fmac_f32 v32, v20, v84
    v_fmac_f32 v48, v20, v85
    v_fma_f32 v32, -v21, v85, v32
    v_fmac_f32 v48, v21, v84
    v_cvt_pk_bf16_f32 v64, v32, -v48
    v_fmac_f32 v33, v20, v32
    v_fmac_f32 v49, v20, v48
    v_fma_f32 v33, -v21, v48, v33
    v_fmac_f32 v49, v21, v32
    v_mov_b32_dpp v65, v64 quad_perm:[1,0,3,2] row_mask:0xf bank_mask:0xf
    v_cvt_pk_bf16_f32 v66, v33, -v49
    v_perm_b32 v64, v65, v64, v9
    ds_write_b32 v8, v64 offset:0
    v_fmac_f32 v34, v20, v33
    v_fmac_f32 v50, v20, v49
    v_fma_f32 v34, -v21, v49, v34
    v_fmac_f32 v50, v21, v33
    v_mov_b32_dpp v67, v66 quad_perm:[1,0,3,2] row_mask:0xf bank_mask:0xf
    v_cvt_pk_bf16_f32 v68, v34, -v50
    v_perm_b32 v66, v67, v66, v9
    ds_write_b32 v8, v66 offset:128
    v_fmac_f32 v35, v20, v34
    v_fmac_f32 v51, v20, v50
    v_fma_f32 v35, -v21, v50, v35
    v_fmac_f32 v51, v21, v34
    v_mov_b32_dpp v69, v68 quad_perm:[1,0,3,2] row_mask:0xf bank_mask:0xf
    v_cvt_pk_bf16_f32 v70, v35, -v51
    v_perm_b32 v68, v69, v68, v9
    ds_write_b32 v8, v68 offset:256
    v_fmac_f32 v36, v20, v35
    v_fmac_f32 v52, v20, v51
    v_fma_f32 v36, -v21, v51, v36
    v_fmac_f32 v52, v21, v35
    v_mov_b32_dpp v71, v70 quad_perm:[1,0,3,2] row_mask:0xf bank_mask:0xf
    v_cvt_pk_bf16_f32 v64, v36, -v52
    v_perm_b32 v70, v71, v70, v9
    ds_write_b32 v8, v70 offset:384
    v_fmac_f32 v37, v20, v36
    v_fmac_f32 v53, v20, v52
    v_fma_f32 v37, -v21, v52, v37
    v_fmac_f32 v53, v21, v36
    v_mov_b32_dpp v65, v64 quad_perm:[1,0,3,2] row_mask:0xf bank_mask:0xf
    v_cvt_pk_bf16_f32 v66, v37, -v53
    v_perm_b32 v64, v65, v64, v9
    ds_write_b32 v8, v64 offset:512
    v_fmac_f32 v38, v20, v37
    v_fmac_f32 v54, v20, v53
    v_fma_f32 v38, -v21, v53, v38
    v_fmac_f32 v54, v21, v37
    v_mov_b32_dpp v67, v66 quad_perm:[1,0,3,2] row_mask:0xf bank_mask:0xf
    v_cvt_pk_bf16_f32 v68, v38, -v54
    v_perm_b32 v66, v67, v66, v9
    ds_write_b32 v8, v66 offset:640
    v_fmac_f32 v39, v20, v38
    v_fmac_f32 v55, v20, v54
    v_fma_f32 v39, -v21, v54, v39
    v_fmac_f32 v55, v21, v38
    v_mov_b32_dpp v69, v68 quad_perm:[1,0,3,2] row_mask:0xf bank_mask:0xf
    v_cvt_pk_bf16_f32 v70, v39, -v55
    v_perm_b32 v68, v69, v68, v9
    ds_write_b32 v8, v68 offset:768
    v_fmac_f32 v40, v20, v39
    v_fmac_f32 v56, v20, v55
    v_fma_f32 v40, -v21, v55, v40
    v_fmac_f32 v56, v21, v39
    v_mov_b32_dpp v71, v70 quad_perm:[1,0,3,2] row_mask:0xf bank_mask:0xf
    v_cvt_pk_bf16_f32 v64, v40, -v56
    v_perm_b32 v70, v71, v70, v9
    ds_write_b32 v8, v70 offset:896
    ds_read_b128 v[72:75], v14
    ds_read_b128 v[76:79], v14 offset:1024
    v_fmac_f32 v41, v20, v40
    v_fmac_f32 v57, v20, v56
    v_fma_f32 v41, -v21, v56, v41
    v_fmac_f32 v57, v21, v40
    v_mov_b32_dpp v65, v64 quad_perm:[1,0,3,2] row_mask:0xf bank_mask:0xf
    v_cvt_pk_bf16_f32 v66, v41, -v57
    v_perm_b32 v64, v65, v64, v9
    ds_write_b32 v8, v64 offset:0
    v_fmac_f32 v42, v20, v41
    v_fmac_f32 v58, v20, v57
    v_fma_f32 v42, -v21, v57, v42
    v_fmac_f32 v58, v21, v41
    v_mov_b32_dpp v67, v66 quad_perm:[1,0,3,2] row_mask:0xf bank_mask:0xf
    v_cvt_pk_bf16_f32 v68, v42, -v58
    v_perm_b32 v66, v67, v66, v9
    ds_write_b32 v8, v66 offset:128
    v_fmac_f32 v43, v20, v42
    v_fmac_f32 v59, v20, v58
    v_fma_f32 v43, -v21, v58, v43
    v_fmac_f32 v59, v21, v42
    v_mov_b32_dpp v69, v68 quad_perm:[1,0,3,2] row_mask:0xf bank_mask:0xf
    v_cvt_pk_bf16_f32 v70, v43, -v59
    s_waitcnt lgkmcnt(0)
    buffer_store_dwordx4 v[72:75], v15, s[56:59], 0 offen offset:0 sc1
    buffer_store_dwordx4 v[76:79], v15, s[56:59], 0 offen offset:2048 sc1
    v_perm_b32 v68, v69, v68, v9
    ds_write_b32 v8, v68 offset:256
    v_fmac_f32 v44, v20, v43
    v_fmac_f32 v60, v20, v59
    v_fma_f32 v44, -v21, v59, v44
    v_fmac_f32 v60, v21, v43
    v_mov_b32_dpp v71, v70 quad_perm:[1,0,3,2] row_mask:0xf bank_mask:0xf
    v_cvt_pk_bf16_f32 v64, v44, -v60
    v_perm_b32 v70, v71, v70, v9
    ds_write_b32 v8, v70 offset:384
    v_fmac_f32 v45, v20, v44
    v_fmac_f32 v61, v20, v60
    v_fma_f32 v45, -v21, v60, v45
    v_fmac_f32 v61, v21, v44
    v_mov_b32_dpp v65, v64 quad_perm:[1,0,3,2] row_mask:0xf bank_mask:0xf
    v_cvt_pk_bf16_f32 v66, v45, -v61
    v_perm_b32 v64, v65, v64, v9
    ds_write_b32 v8, v64 offset:512
    v_fmac_f32 v46, v20, v45
    v_fmac_f32 v62, v20, v61
    v_fma_f32 v46, -v21, v61, v46
    v_fmac_f32 v62, v21, v45
    v_mov_b32_dpp v67, v66 quad_perm:[1,0,3,2] row_mask:0xf bank_mask:0xf
    v_cvt_pk_bf16_f32 v68, v46, -v62
    v_perm_b32 v66, v67, v66, v9
    ds_write_b32 v8, v66 offset:640
    v_fmac_f32 v47, v20, v46
    v_fmac_f32 v63, v20, v62
    v_fma_f32 v47, -v21, v62, v47
    v_fmac_f32 v63, v21, v46
    v_mov_b32_dpp v69, v68 quad_perm:[1,0,3,2] row_mask:0xf bank_mask:0xf
    v_cvt_pk_bf16_f32 v70, v47, -v63
    v_perm_b32 v68, v69, v68, v9
    ds_write_b32 v8, v68 offset:768
    v_mov_b32_dpp v71, v70 quad_perm:[1,0,3,2] row_mask:0xf bank_mask:0xf
    v_perm_b32 v70, v71, v70, v9
    ds_write_b32 v8, v70 offset:896
    ds_read_b128 v[88:91], v14
    ds_read_b128 v[92:95], v14 offset:1024
    s_waitcnt lgkmcnt(0)
    buffer_store_dwordx4 v[88:91], v15, s[56:59], 0 offen offset:1024 sc1
    buffer_store_dwordx4 v[92:95], v15, s[56:59], 0 offen offset:3072 sc1
    global_load_ushort v31, v122, s[38:39]
    global_load_ushort v96, v123, s[8:9] offset:-4096
    global_load_ushort v97, v123, s[8:9] offset:-3072
    global_load_ushort v98, v123, s[8:9] offset:-2048
    global_load_ushort v99, v123, s[8:9] offset:-1024
    global_load_ushort v100, v123, s[8:9] offset:0
    global_load_ushort v101, v123, s[8:9] offset:1024
    global_load_ushort v102, v123, s[8:9] offset:2048
    global_load_ushort v103, v123, s[8:9] offset:3072
    global_load_ushort v104, v124, s[8:9] offset:-4096
    global_load_ushort v105, v124, s[8:9] offset:-3072
    global_load_ushort v106, v124, s[8:9] offset:-2048
    global_load_ushort v107, v124, s[8:9] offset:-1024
    global_load_ushort v108, v124, s[8:9] offset:0
    global_load_ushort v109, v124, s[8:9] offset:1024
    global_load_ushort v110, v124, s[8:9] offset:2048
    global_load_ushort v111, v124, s[8:9] offset:3072
    s_cmp_lg_u32 s50, 0
    s_cbranch_scc1 L_g32
    v_mov_b32 v120, 0
    v_lshlrev_b32 v121, 16, v232
    v_lshlrev_b32 v122, 16, v248
    v_and_b32 v123, 0xffff0000, v232
    v_and_b32 v124, 0xffff0000, v248
    v_mul_f32 v121, v121, v122
    v_mul_f32 v123, v123, v124
    v_cvt_pk_bf16_f32 v121, v121, v123
    v_lshlrev_b32 v122, 16, v121
    v_and_b32 v123, 0xffff0000, v121
    v_add_f32 v120, v120, v122
    v_add_f32 v120, v120, v123
    v_lshlrev_b32 v121, 16, v233
    v_lshlrev_b32 v122, 16, v249
    v_and_b32 v123, 0xffff0000, v233
    v_and_b32 v124, 0xffff0000, v249
    v_mul_f32 v121, v121, v122
    v_mul_f32 v123, v123, v124
    v_cvt_pk_bf16_f32 v121, v121, v123
    v_lshlrev_b32 v122, 16, v121
    v_and_b32 v123, 0xffff0000, v121
    v_add_f32 v120, v120, v122
    v_add_f32 v120, v120, v123
    v_lshlrev_b32 v121, 16, v234
    v_lshlrev_b32 v122, 16, v250
    v_and_b32 v123, 0xffff0000, v234
    v_and_b32 v124, 0xffff0000, v250
    v_mul_f32 v121, v121, v122
    v_mul_f32 v123, v123, v124
    v_cvt_pk_bf16_f32 v121, v121, v123
    v_lshlrev_b32 v122, 16, v121
    v_and_b32 v123, 0xffff0000, v121
    v_add_f32 v120, v120, v122
    v_add_f32 v120, v120, v123
    v_lshlrev_b32 v121, 16, v235
    v_lshlrev_b32 v122, 16, v251
    v_and_b32 v123, 0xffff0000, v235
    v_and_b32 v124, 0xffff0000, v251
    v_mul_f32 v121, v121, v122
    v_mul_f32 v123, v123, v124
    v_cvt_pk_bf16_f32 v121, v121, v123
    v_lshlrev_b32 v122, 16, v121
    v_and_b32 v123, 0xffff0000, v121
    v_add_f32 v120, v120, v122
    v_add_f32 v120, v120, v123
    v_lshlrev_b32 v121, 16, v236
    v_lshlrev_b32 v122, 16, v252
    v_and_b32 v123, 0xffff0000, v236
    v_and_b32 v124, 0xffff0000, v252
    v_mul_f32 v121, v121, v122
    v_mul_f32 v123, v123, v124
    v_cvt_pk_bf16_f32 v121, v121, v123
    v_lshlrev_b32 v122, 16, v121
    v_and_b32 v123, 0xffff0000, v121
    v_add_f32 v120, v120, v122
    v_add_f32 v120, v120, v123
    v_lshlrev_b32 v121, 16, v237
    v_lshlrev_b32 v122, 16, v253
    v_and_b32 v123, 0xffff0000, v237
    v_and_b32 v124, 0xffff0000, v253
    v_mul_f32 v121, v121, v122
    v_mul_f32 v123, v123, v124
    v_cvt_pk_bf16_f32 v121, v121, v123
    v_lshlrev_b32 v122, 16, v121
    v_and_b32 v123, 0xffff0000, v121
    v_add_f32 v120, v120, v122
    v_add_f32 v120, v120, v123
    v_lshlrev_b32 v121, 16, v238
    v_lshlrev_b32 v122, 16, v254
    v_and_b32 v123, 0xffff0000, v238
    v_and_b32 v124, 0xffff0000, v254
    v_mul_f32 v121, v121, v122
    v_mul_f32 v123, v123, v124
    v_cvt_pk_bf16_f32 v121, v121, v123
    v_lshlrev_b32 v122, 16, v121
    v_and_b32 v123, 0xffff0000, v121
    v_add_f32 v120, v120, v122
    v_add_f32 v120, v120, v123
    v_lshlrev_b32 v121, 16, v239
    v_lshlrev_b32 v122, 16, v255
    v_and_b32 v123, 0xffff0000, v239
    v_and_b32 v124, 0xffff0000, v255
    v_mul_f32 v121, v121, v122
    v_mul_f32 v123, v123, v124
    v_cvt_pk_bf16_f32 v121, v121, v123
    v_lshlrev_b32 v122, 16, v121
    v_and_b32 v123, 0xffff0000, v121
    v_add_f32 v120, v120, v122
    v_add_f32 v120, v120, v123
    ds_swizzle_b32 v121, v120 offset:1055
    s_waitcnt lgkmcnt(0)
    v_add_f32 v120, v120, v121
    ds_swizzle_b32 v121, v120 offset:2079
    s_waitcnt lgkmcnt(0)
    v_add_f32 v120, v120, v121
    ds_swizzle_b32 v121, v120 offset:4127
    s_waitcnt lgkmcnt(0)
    v_add_f32 v120, v120, v121
    ds_swizzle_b32 v121, v120 offset:8223
    s_waitcnt lgkmcnt(0)
    v_add_f32 v120, v120, v121
    ds_swizzle_b32 v121, v120 offset:16415
    s_waitcnt lgkmcnt(0)
    v_add_f32 v120, v120, v121
    v_cvt_pk_bf16_f32 v120, v120, v120
    v_and_b32 v120, 0xffff0000, v120
    v_mul_f32 v120, 3216550459, v120
    v_exp_f32 v120, v120
    s_nop 0
    v_add_f32 v120, 1.0, v120
    v_rcp_f32 v116, v120
    s_nop 0
    v_cvt_pk_bf16_f32 v116, v116, v116
    v_and_b32 v116, 0xffff0000, v116
    s_lshl_b32 s3, s50, 3
    s_add_u32 s3, s3, 75776
    v_lshl_add_u32 v112, v3, 2, s3
    ds_write_b32 v112, v116
L_g32:
    s_lshl_b32 s3, s51, 11
    s_add_u32 s3, s3, 6324224
    v_lshrrev_b32 v14, 2, v1
    v_lshlrev_b32 v14, 7, v14
    v_and_b32 v21, 3, v1
    v_lshl_add_u32 v14, v21, 3, v14
    v_add_u32 v14, s3, v14
    s_lshl_b32 s4, s52, 7
    s_add_u32 s3, s3, s4
    v_and_b32 v20, 7, v1
    v_lshl_add_u32 v19, v20, 2, s3
    v_lshlrev_b32 v20, 2, v20
    v_add_u32 v20, 75776, v20
    v_mov_b32 v30, v83
    s_and_b32 s3, s52, 7
    s_lshl_b32 s3, s3, 12
    s_add_u32 s3, s3, 6291456
    v_lshl_add_u32 v18, v2, 7, s3
    v_mul_u32_u24 v21, 48, v1
    v_add_u32 v15, v15, v21
    s_waitcnt vmcnt(17) lgkmcnt(0)
    buffer_load_dword v28, v15, s[56:59], 0 offen
    s_barrier
    s_cmp_lg_u32 s50, 0
    s_cbranch_scc1 L_g9
    ds_read_b32 v20, v20
    s_mov_b64 exec, 0xff
    s_waitcnt lgkmcnt(0)
    global_store_dword v19, v20, s[46:47] sc1
    s_mov_b64 exec, -1
    s_mov_b32 s64, s32
    s_mov_b32 s65, s33
    s_mov_b32 s66, 524288
    s_mov_b32 s67, 0x00020000
    s_add_u32 m0, s54, 0
    s_movk_i32 s61, 0
    buffer_load_dwordx4 v4, s[64:67], s61 offen offset:0 lds
    buffer_load_dwordx4 v5, s[64:67], s61 offen offset:1024 lds
    buffer_load_dwordx4 v6, s[64:67], s61 offen offset:2048 lds
    buffer_load_dwordx4 v7, s[64:67], s61 offen offset:3072 lds
    s_add_u32 m0, s54, 4096
    s_movk_i32 s61, 128
    buffer_load_dwordx4 v4, s[64:67], s61 offen offset:0 lds
    buffer_load_dwordx4 v5, s[64:67], s61 offen offset:1024 lds
    buffer_load_dwordx4 v6, s[64:67], s61 offen offset:2048 lds
    buffer_load_dwordx4 v7, s[64:67], s61 offen offset:3072 lds
    s_add_u32 m0, s54, 8192
    s_movk_i32 s61, 256
    buffer_load_dwordx4 v4, s[64:67], s61 offen offset:0 lds
    buffer_load_dwordx4 v5, s[64:67], s61 offen offset:1024 lds
    buffer_load_dwordx4 v6, s[64:67], s61 offen offset:2048 lds
    buffer_load_dwordx4 v7, s[64:67], s61 offen offset:3072 lds
    s_add_u32 m0, s54, 12288
    s_movk_i32 s61, 384
    buffer_load_dwordx4 v4, s[64:67], s61 offen offset:0 lds
    buffer_load_dwordx4 v5, s[64:67], s61 offen offset:1024 lds
    buffer_load_dwordx4 v6, s[64:67], s61 offen offset:2048 lds
    buffer_load_dwordx4 v7, s[64:67], s61 offen offset:3072 lds
    s_waitcnt vmcnt(0)
L_g9:
    s_setprio 0
    ds_read_b128 v[128:131], v10 offset:0
    ds_read_b128 v[132:135], v11 offset:0
    ds_read_b128 v[144:147], v12 offset:0
    ds_read_b128 v[148:151], v13 offset:0
    ds_read_b128 v[160:163], v10 offset:4096
    ds_read_b128 v[164:167], v11 offset:4096
    ds_read_b128 v[176:179], v12 offset:4096
    ds_read_b128 v[180:183], v13 offset:4096
    ds_read_b128 v[192:195], v10 offset:8192
    ds_read_b128 v[196:199], v11 offset:8192
    ds_read_b128 v[208:211], v12 offset:8192
    ds_read_b128 v[212:215], v13 offset:8192
    ds_read_b128 v[224:227], v10 offset:12288
    ds_read_b128 v[228:231], v11 offset:12288
    ds_read_b128 v[240:243], v12 offset:12288
    ds_read_b128 v[244:247], v13 offset:12288
    s_mov_b32 s64, s34
    s_mov_b32 s65, s35
    s_mov_b32 s66, 524288
    s_mov_b32 s67, 0x00020000
    s_waitcnt lgkmcnt(0)
    s_add_u32 m0, s54, 0
    s_movk_i32 s61, 0
    buffer_load_dwordx4 v4, s[64:67], s61 offen offset:0 lds
    buffer_load_dwordx4 v5, s[64:67], s61 offen offset:1024 lds
    buffer_load_dwordx4 v6, s[64:67], s61 offen offset:2048 lds
    buffer_load_dwordx4 v7, s[64:67], s61 offen offset:3072 lds
    s_add_u32 m0, s54, 4096
    s_movk_i32 s61, 128
    buffer_load_dwordx4 v4, s[64:67], s61 offen offset:0 lds
    buffer_load_dwordx4 v5, s[64:67], s61 offen offset:1024 lds
    buffer_load_dwordx4 v6, s[64:67], s61 offen offset:2048 lds
    buffer_load_dwordx4 v7, s[64:67], s61 offen offset:3072 lds
    s_add_u32 m0, s54, 8192
    s_movk_i32 s61, 256
    buffer_load_dwordx4 v4, s[64:67], s61 offen offset:0 lds
    buffer_load_dwordx4 v5, s[64:67], s61 offen offset:1024 lds
    buffer_load_dwordx4 v6, s[64:67], s61 offen offset:2048 lds
    buffer_load_dwordx4 v7, s[64:67], s61 offen offset:3072 lds
    s_add_u32 m0, s54, 12288
    s_movk_i32 s61, 384
    buffer_load_dwordx4 v4, s[64:67], s61 offen offset:0 lds
    buffer_load_dwordx4 v5, s[64:67], s61 offen offset:1024 lds
    buffer_load_dwordx4 v6, s[64:67], s61 offen offset:2048 lds
    buffer_load_dwordx4 v7, s[64:67], s61 offen offset:3072 lds
    s_cmp_lg_u32 s50, 0
    s_cbranch_scc1 L_g26
    global_load_dwordx2 v[22:23], v14, s[46:47] sc1
    global_load_dword v19, v18, s[46:47] sc1
L_g26:
    s_waitcnt vmcnt(16)
    v_bfe_u32 v29, v1, 3, 2
    v_lshl_add_u32 v29, v3, 4, v29
    v_lshl_add_u32 v4, v29, 7, v118
    s_lshl_b32 s3, s49, 11
    s_lshl_b32 s4, s62, 16
    s_add_u32 s3, s3, s4
    s_lshl_b32 s4, s63, 12
    s_add_u32 s3, s3, s4
    s_add_u32 s3, s3, 12582912
    v_add_u32 v4, s3, v4
    v_xor_b32 v5, 64, v4
    v_subrev_u32 v5, 512, v5
    v_subrev_u32 v6, 1024, v4
    v_subrev_u32 v7, 1024, v5
    s_lshl_b32 s54, s62, 13
    s_lshl_b32 s3, s63, 12
    s_add_u32 s55, s54, s3
    v_lshlrev_b32 v31, 16, v31
    v_lshlrev_b32 v24, 16, v96
    v_lshlrev_b32 v25, 16, v97
    v_mul_f32 v24, v24, v31
    v_mul_f32 v25, v25, v31
    v_cvt_pk_bf16_f32 v24, v24, v25
    v_lshlrev_b32 v96, 16, v24
    v_and_b32 v97, 0xffff0000, v24
    v_lshlrev_b32 v24, 16, v98
    v_lshlrev_b32 v25, 16, v99
    v_mul_f32 v24, v24, v31
    v_mul_f32 v25, v25, v31
    v_cvt_pk_bf16_f32 v24, v24, v25
    v_lshlrev_b32 v98, 16, v24
    v_and_b32 v99, 0xffff0000, v24
    v_lshlrev_b32 v24, 16, v100
    v_lshlrev_b32 v25, 16, v101
    v_mul_f32 v24, v24, v31
    v_mul_f32 v25, v25, v31
    v_cvt_pk_bf16_f32 v24, v24, v25
    v_lshlrev_b32 v100, 16, v24
    v_and_b32 v101, 0xffff0000, v24
    v_lshlrev_b32 v24, 16, v102
    v_lshlrev_b32 v25, 16, v103
    v_mul_f32 v24, v24, v31
    v_mul_f32 v25, v25, v31
    v_cvt_pk_bf16_f32 v24, v24, v25
    v_lshlrev_b32 v102, 16, v24
    v_and_b32 v103, 0xffff0000, v24
    v_lshlrev_b32 v24, 16, v104
    v_lshlrev_b32 v25, 16, v105
    v_mul_f32 v24, v24, v31
    v_mul_f32 v25, v25, v31
    v_cvt_pk_bf16_f32 v24, v24, v25
    v_lshlrev_b32 v104, 16, v24
    v_and_b32 v105, 0xffff0000, v24
    v_lshlrev_b32 v24, 16, v106
    v_lshlrev_b32 v25, 16, v107
    v_mul_f32 v24, v24, v31
    v_mul_f32 v25, v25, v31
    v_cvt_pk_bf16_f32 v24, v24, v25
    v_lshlrev_b32 v106, 16, v24
    v_and_b32 v107, 0xffff0000, v24
    v_lshlrev_b32 v24, 16, v108
    v_lshlrev_b32 v25, 16, v109
    v_mul_f32 v24, v24, v31
    v_mul_f32 v25, v25, v31
    v_cvt_pk_bf16_f32 v24, v24, v25
    v_lshlrev_b32 v108, 16, v24
    v_and_b32 v109, 0xffff0000, v24
    v_lshlrev_b32 v24, 16, v110
    v_lshlrev_b32 v25, 16, v111
    v_mul_f32 v24, v24, v31
    v_mul_f32 v25, v25, v31
    v_cvt_pk_bf16_f32 v24, v24, v25
    v_lshlrev_b32 v110, 16, v24
    v_and_b32 v111, 0xffff0000, v24
    s_waitcnt vmcnt(0)
    ds_read_b128 v[136:139], v10 offset:0
    ds_read_b128 v[140:143], v11 offset:0
    ds_read_b128 v[152:155], v12 offset:0
    ds_read_b128 v[156:159], v13 offset:0
    ds_read_b128 v[168:171], v10 offset:4096
    ds_read_b128 v[172:175], v11 offset:4096
    ds_read_b128 v[184:187], v12 offset:4096
    ds_read_b128 v[188:191], v13 offset:4096
    ds_read_b128 v[200:203], v10 offset:8192
    ds_read_b128 v[204:207], v11 offset:8192
    ds_read_b128 v[216:219], v12 offset:8192
    ds_read_b128 v[220:223], v13 offset:8192
    ds_read_b128 v[232:235], v10 offset:12288
    ds_read_b128 v[236:239], v11 offset:12288
    ds_read_b128 v[248:251], v12 offset:12288
    ds_read_b128 v[252:255], v13 offset:12288
    v_bfe_u32 v10, v2, 1, 3
    v_xor_b32 v10, v10, v3
    v_lshlrev_b32 v10, 4, v10
    v_lshl_add_u32 v10, v2, 7, v10
    v_add_u32 v10, s54, v10
    v_xor_b32 v11, 32, v10
    v_xor_b32 v12, 64, v10
    v_xor_b32 v13, 96, v10
    s_cmp_lg_u32 s50, 0
    s_cbranch_scc1 L_g11
L_g10:
    s_waitcnt vmcnt(0)
    v_max_u32 v21, v22, v23
    v_cmp_eq_u32 vcc, -1, v21
    s_add_u32 s69, s69, 1
    s_cmp_lt_u32 s69, 0x400000
    s_cbranch_vccz L_g22
    global_load_dwordx2 v[22:23], v14, s[46:47] sc1
    global_load_dword v19, v18, s[46:47] sc1
    s_cbranch_scc1 L_g10
    s_waitcnt vmcnt(0)
L_g22:
    v_lshlrev_b32 v21, 3, v1
    v_add_u32 v21, 76160, v21
    v_cmp_ne_u32 vcc, 3, v19
    ds_write_b64 v21, v[22:23]
    v_mov_b32 v21, 76096
    v_mov_b32 v22, vcc_lo
    ds_write_b32 v21, v22
L_g11:
    v_mov_b32 v21, 76096
    s_waitcnt vmcnt(0) lgkmcnt(0)
    s_barrier
    ds_read_b32 v21, v21
    ds_read_b128 v[112:115], v17 offset:0
    ds_read_b128 v[116:119], v17 offset:16
    ds_read_b128 v[120:123], v17 offset:32
    ds_read_b128 v[124:127], v17 offset:48
    s_waitcnt lgkmcnt(0)
    v_readfirstlane_b32 s60, v21
    v_cmp_eq_u32 vcc, 0, v21
    s_nop 1
    v_cndmask_b32 v15, v14, v16, vcc
    s_add_u32 m0, s55, 0
    s_mov_b32 s3, 0
    buffer_load_dwordx4 v4, s[56:59], s3 offen offset:0 sc1 lds
    buffer_load_dwordx4 v5, s[56:59], s3 offen offset:1024 sc1 lds
    buffer_load_dwordx4 v6, s[56:59], s3 offen offset:2048 sc1 lds
    buffer_load_dwordx4 v7, s[56:59], s3 offen offset:3072 sc1 lds
    s_add_u32 m0, s55, 16384
    s_mov_b32 s3, 8192
    buffer_load_dwordx4 v4, s[56:59], s3 offen offset:0 sc1 lds
    buffer_load_dwordx4 v5, s[56:59], s3 offen offset:1024 sc1 lds
    buffer_load_dwordx4 v6, s[56:59], s3 offen offset:2048 sc1 lds
    buffer_load_dwordx4 v7, s[56:59], s3 offen offset:3072 sc1 lds
    s_waitcnt vmcnt(4)
    s_barrier
    ds_read_b128 v[64:67], v10 offset:0
    ds_read_b128 v[68:71], v10 offset:4096
    ds_read_b128 v[72:75], v11 offset:0
    ds_read_b128 v[76:79], v11 offset:4096
    ds_read_b128 v[80:83], v12 offset:0
    ds_read_b128 v[84:87], v12 offset:4096
    ds_read_b128 v[88:91], v13 offset:0
    ds_read_b128 v[92:95], v13 offset:4096
    s_add_u32 m0, s55, 32768
    s_mov_b32 s3, 16384
    buffer_load_dwordx4 v4, s[56:59], s3 offen offset:0 sc1 lds
    buffer_load_dwordx4 v5, s[56:59], s3 offen offset:1024 sc1 lds
    buffer_load_dwordx4 v6, s[56:59], s3 offen offset:2048 sc1 lds
    buffer_load_dwordx4 v7, s[56:59], s3 offen offset:3072 sc1 lds
    s_waitcnt vmcnt(4)
    s_barrier
    s_waitcnt lgkmcnt(7)
    v_mfma_f32_32x32x16_bf16 v[32:47], v[64:67], v[128:131], 0
    ds_read_b128 v[64:67], v10 offset:16384
    s_add_u32 m0, s55, 49152
    s_mov_b32 s3, 24576
    buffer_load_dwordx4 v4, s[56:59], s3 offen offset:0 sc1 lds
    s_waitcnt lgkmcnt(7)
    v_mfma_f32_32x32x16_bf16 v[48:63], v[68:71], v[128:131], 0
    ds_read_b128 v[68:71], v10 offset:20480
    s_waitcnt lgkmcnt(7)
    v_mfma_f32_32x32x16_bf16 v[32:47], v[72:75], v[132:135], v[32:47]
    ds_read_b128 v[72:75], v11 offset:16384
    buffer_load_dwordx4 v5, s[56:59], s3 offen offset:1024 sc1 lds
    s_waitcnt lgkmcnt(7)
    v_mfma_f32_32x32x16_bf16 v[48:63], v[76:79], v[132:135], v[48:63]
    ds_read_b128 v[76:79], v11 offset:20480
    s_waitcnt lgkmcnt(7)
    v_mfma_f32_32x32x16_bf16 v[32:47], v[80:83], v[136:139], v[32:47]
    ds_read_b128 v[80:83], v12 offset:16384
    buffer_load_dwordx4 v6, s[56:59], s3 offen offset:2048 sc1 lds
    s_waitcnt lgkmcnt(7)
    v_mfma_f32_32x32x16_bf16 v[48:63], v[84:87], v[136:139], v[48:63]
    ds_read_b128 v[84:87], v12 offset:20480
    s_waitcnt lgkmcnt(7)
    v_mfma_f32_32x32x16_bf16 v[32:47], v[88:91], v[140:143], v[32:47]
    ds_read_b128 v[88:91], v13 offset:16384
    buffer_load_dwordx4 v7, s[56:59], s3 offen offset:3072 sc1 lds
    s_waitcnt lgkmcnt(7)
    v_mfma_f32_32x32x16_bf16 v[48:63], v[92:95], v[140:143], v[48:63]
    ds_read_b128 v[92:95], v13 offset:20480
    s_waitcnt vmcnt(4)
    s_barrier
    s_waitcnt lgkmcnt(7)
    v_mfma_f32_32x32x16_bf16 v[32:47], v[64:67], v[144:147], v[32:47]
    ds_read_b128 v[64:67], v10 offset:32768
    s_add_u32 m0, s55, 0
    s_mov_b32 s3, 32768
    buffer_load_dwordx4 v4, s[56:59], s3 offen offset:0 sc1 lds
    s_waitcnt lgkmcnt(7)
    v_mfma_f32_32x32x16_bf16 v[48:63], v[68:71], v[144:147], v[48:63]
    ds_read_b128 v[68:71], v10 offset:36864
    s_waitcnt lgkmcnt(7)
    v_mfma_f32_32x32x16_bf16 v[32:47], v[72:75], v[148:151], v[32:47]
    ds_read_b128 v[72:75], v11 offset:32768
    buffer_load_dwordx4 v5, s[56:59], s3 offen offset:1024 sc1 lds
    s_waitcnt lgkmcnt(7)
    v_mfma_f32_32x32x16_bf16 v[48:63], v[76:79], v[148:151], v[48:63]
    ds_read_b128 v[76:79], v11 offset:36864
    s_waitcnt lgkmcnt(7)
    v_mfma_f32_32x32x16_bf16 v[32:47], v[80:83], v[152:155], v[32:47]
    ds_read_b128 v[80:83], v12 offset:32768
    buffer_load_dwordx4 v6, s[56:59], s3 offen offset:2048 sc1 lds
    s_waitcnt lgkmcnt(7)
    v_mfma_f32_32x32x16_bf16 v[48:63], v[84:87], v[152:155], v[48:63]
    ds_read_b128 v[84:87], v12 offset:36864
    s_waitcnt lgkmcnt(7)
    v_mfma_f32_32x32x16_bf16 v[32:47], v[88:91], v[156:159], v[32:47]
    ds_read_b128 v[88:91], v13 offset:32768
    buffer_load_dwordx4 v7, s[56:59], s3 offen offset:3072 sc1 lds
    s_waitcnt lgkmcnt(7)
    v_mfma_f32_32x32x16_bf16 v[48:63], v[92:95], v[156:159], v[48:63]
    ds_read_b128 v[92:95], v13 offset:36864
    s_waitcnt vmcnt(4)
    s_barrier
    s_waitcnt lgkmcnt(7)
    v_mfma_f32_32x32x16_bf16 v[32:47], v[64:67], v[160:163], v[32:47]
    ds_read_b128 v[64:67], v10 offset:49152
    s_add_u32 m0, s55, 16384
    s_mov_b32 s3, 40960
    buffer_load_dwordx4 v4, s[56:59], s3 offen offset:0 sc1 lds
    v_sub_f32 v28, 1.0, v112
    s_waitcnt lgkmcnt(7)
    v_mfma_f32_32x32x16_bf16 v[48:63], v[68:71], v[160:163], v[48:63]
    ds_read_b128 v[68:71], v10 offset:53248
    v_sub_f32 v29, 1.0, v113
    s_waitcnt lgkmcnt(7)
    v_mfma_f32_32x32x16_bf16 v[32:47], v[72:75], v[164:167], v[32:47]
    ds_read_b128 v[72:75], v11 offset:49152
    buffer_load_dwordx4 v5, s[56:59], s3 offen offset:1024 sc1 lds
    v_cvt_pk_bf16_f32 v28, v28, v29
    s_waitcnt lgkmcnt(7)
    v_mfma_f32_32x32x16_bf16 v[48:63], v[76:79], v[164:167], v[48:63]
    ds_read_b128 v[76:79], v11 offset:53248
    v_lshlrev_b32 v128, 16, v28
    s_waitcnt lgkmcnt(7)
    v_mfma_f32_32x32x16_bf16 v[32:47], v[80:83], v[168:171], v[32:47]
    ds_read_b128 v[80:83], v12 offset:49152
    buffer_load_dwordx4 v6, s[56:59], s3 offen offset:2048 sc1 lds
    v_and_b32 v129, 0xffff0000, v28
    s_waitcnt lgkmcnt(7)
    v_mfma_f32_32x32x16_bf16 v[48:63], v[84:87], v[168:171], v[48:63]
    ds_read_b128 v[84:87], v12 offset:53248
    v_sub_f32 v28, 1.0, v114
    s_waitcnt lgkmcnt(7)
    v_mfma_f32_32x32x16_bf16 v[32:47], v[88:91], v[172:175], v[32:47]
    ds_read_b128 v[88:91], v13 offset:49152
    buffer_load_dwordx4 v7, s[56:59], s3 offen offset:3072 sc1 lds
    v_sub_f32 v29, 1.0, v115
    s_waitcnt lgkmcnt(7)
    v_mfma_f32_32x32x16_bf16 v[48:63], v[92:95], v[172:175], v[48:63]
    ds_read_b128 v[92:95], v13 offset:53248
    v_cvt_pk_bf16_f32 v28, v28, v29
    s_waitcnt vmcnt(4)
    s_barrier
    s_waitcnt lgkmcnt(7)
    v_mfma_f32_32x32x16_bf16 v[32:47], v[64:67], v[176:179], v[32:47]
    ds_read_b128 v[64:67], v10 offset:0
    s_add_u32 m0, s55, 32768
    s_mov_b32 s3, 49152
    buffer_load_dwordx4 v4, s[56:59], s3 offen offset:0 sc1 lds
    v_lshlrev_b32 v130, 16, v28
    s_waitcnt lgkmcnt(7)
    v_mfma_f32_32x32x16_bf16 v[48:63], v[68:71], v[176:179], v[48:63]
    ds_read_b128 v[68:71], v10 offset:4096
    v_and_b32 v131, 0xffff0000, v28
    s_waitcnt lgkmcnt(7)
    v_mfma_f32_32x32x16_bf16 v[32:47], v[72:75], v[180:183], v[32:47]
    ds_read_b128 v[72:75], v11 offset:0
    buffer_load_dwordx4 v5, s[56:59], s3 offen offset:1024 sc1 lds
    v_sub_f32 v28, 1.0, v116
    s_waitcnt lgkmcnt(7)
    v_mfma_f32_32x32x16_bf16 v[48:63], v[76:79], v[180:183], v[48:63]
    ds_read_b128 v[76:79], v11 offset:4096
    v_sub_f32 v29, 1.0, v117
    s_waitcnt lgkmcnt(7)
    v_mfma_f32_32x32x16_bf16 v[32:47], v[80:83], v[184:187], v[32:47]
    ds_read_b128 v[80:83], v12 offset:0
    buffer_load_dwordx4 v6, s[56:59], s3 offen offset:2048 sc1 lds
    v_cvt_pk_bf16_f32 v28, v28, v29
    s_waitcnt lgkmcnt(7)
    v_mfma_f32_32x32x16_bf16 v[48:63], v[84:87], v[184:187], v[48:63]
    ds_read_b128 v[84:87], v12 offset:4096
    v_lshlrev_b32 v132, 16, v28
    s_waitcnt lgkmcnt(7)
    v_mfma_f32_32x32x16_bf16 v[32:47], v[88:91], v[188:191], v[32:47]
    ds_read_b128 v[88:91], v13 offset:0
    buffer_load_dwordx4 v7, s[56:59], s3 offen offset:3072 sc1 lds
    v_and_b32 v133, 0xffff0000, v28
    s_waitcnt lgkmcnt(7)
    v_mfma_f32_32x32x16_bf16 v[48:63], v[92:95], v[188:191], v[48:63]
    ds_read_b128 v[92:95], v13 offset:4096
    v_sub_f32 v28, 1.0, v118
    s_waitcnt vmcnt(4)
    s_barrier
    s_waitcnt lgkmcnt(7)
    v_mfma_f32_32x32x16_bf16 v[32:47], v[64:67], v[192:195], v[32:47]
    ds_read_b128 v[64:67], v10 offset:16384
    s_add_u32 m0, s55, 49152
    s_mov_b32 s3, 57344
    buffer_load_dwordx4 v4, s[56:59], s3 offen offset:0 sc1 lds
    v_sub_f32 v29, 1.0, v119
    s_waitcnt lgkmcnt(7)
    v_mfma_f32_32x32x16_bf16 v[48:63], v[68:71], v[192:195], v[48:63]
    ds_read_b128 v[68:71], v10 offset:20480
    v_cvt_pk_bf16_f32 v28, v28, v29
    s_waitcnt lgkmcnt(7)
    v_mfma_f32_32x32x16_bf16 v[32:47], v[72:75], v[196:199], v[32:47]
    ds_read_b128 v[72:75], v11 offset:16384
    buffer_load_dwordx4 v5, s[56:59], s3 offen offset:1024 sc1 lds
    v_lshlrev_b32 v134, 16, v28
    s_waitcnt lgkmcnt(7)
    v_mfma_f32_32x32x16_bf16 v[48:63], v[76:79], v[196:199], v[48:63]
    ds_read_b128 v[76:79], v11 offset:20480
    v_and_b32 v135, 0xffff0000, v28
    s_waitcnt lgkmcnt(7)
    v_mfma_f32_32x32x16_bf16 v[32:47], v[80:83], v[200:203], v[32:47]
    ds_read_b128 v[80:83], v12 offset:16384
    buffer_load_dwordx4 v6, s[56:59], s3 offen offset:2048 sc1 lds
    v_sub_f32 v28, 1.0, v120
    s_waitcnt lgkmcnt(7)
    v_mfma_f32_32x32x16_bf16 v[48:63], v[84:87], v[200:203], v[48:63]
    ds_read_b128 v[84:87], v12 offset:20480
    v_sub_f32 v29, 1.0, v121
    s_waitcnt lgkmcnt(7)
    v_mfma_f32_32x32x16_bf16 v[32:47], v[88:91], v[204:207], v[32:47]
    ds_read_b128 v[88:91], v13 offset:16384
    buffer_load_dwordx4 v7, s[56:59], s3 offen offset:3072 sc1 lds
    v_cvt_pk_bf16_f32 v28, v28, v29
    s_waitcnt lgkmcnt(7)
    v_mfma_f32_32x32x16_bf16 v[48:63], v[92:95], v[204:207], v[48:63]
    ds_read_b128 v[92:95], v13 offset:20480
    v_lshlrev_b32 v136, 16, v28
    s_cmp_eq_u32 s60, 0
    s_cbranch_scc1 L_g33
    global_load_dword v19, v18, s[46:47] sc1
    s_waitcnt vmcnt(0)
    v_cmp_ne_u32 vcc, 3, v19
    s_nop 1
    s_cbranch_vccnz L_g33
    s_mov_b32 s60, 0
    v_mov_b32 v15, v16
L_g33:
    global_load_dwordx4 v[20:23], v15, s[46:47] sc1
    global_load_dwordx4 v[24:27], v15, s[46:47] offset:16 sc1
    s_waitcnt vmcnt(6)
    s_barrier
    s_waitcnt lgkmcnt(7)
    v_mfma_f32_32x32x16_bf16 v[32:47], v[64:67], v[208:211], v[32:47]
    ds_read_b128 v[64:67], v10 offset:32768
    v_and_b32 v137, 0xffff0000, v28
    s_waitcnt lgkmcnt(7)
    v_mfma_f32_32x32x16_bf16 v[48:63], v[68:71], v[208:211], v[48:63]
    ds_read_b128 v[68:71], v10 offset:36864
    v_sub_f32 v28, 1.0, v122
    s_waitcnt lgkmcnt(7)
    v_mfma_f32_32x32x16_bf16 v[32:47], v[72:75], v[212:215], v[32:47]
    ds_read_b128 v[72:75], v11 offset:32768
    v_sub_f32 v29, 1.0, v123
    s_waitcnt lgkmcnt(7)
    v_mfma_f32_32x32x16_bf16 v[48:63], v[76:79], v[212:215], v[48:63]
    ds_read_b128 v[76:79], v11 offset:36864
    v_cvt_pk_bf16_f32 v28, v28, v29
    s_waitcnt lgkmcnt(7)
    v_mfma_f32_32x32x16_bf16 v[32:47], v[80:83], v[216:219], v[32:47]
    ds_read_b128 v[80:83], v12 offset:32768
    v_lshlrev_b32 v138, 16, v28
    s_waitcnt lgkmcnt(7)
    v_mfma_f32_32x32x16_bf16 v[48:63], v[84:87], v[216:219], v[48:63]
    ds_read_b128 v[84:87], v12 offset:36864
    v_and_b32 v139, 0xffff0000, v28
    s_waitcnt lgkmcnt(7)
    v_mfma_f32_32x32x16_bf16 v[32:47], v[88:91], v[220:223], v[32:47]
    ds_read_b128 v[88:91], v13 offset:32768
    v_sub_f32 v28, 1.0, v124
    s_waitcnt lgkmcnt(7)
    v_mfma_f32_32x32x16_bf16 v[48:63], v[92:95], v[220:223], v[48:63]
    ds_read_b128 v[92:95], v13 offset:36864
    v_sub_f32 v29, 1.0, v125
    s_waitcnt vmcnt(2)
    s_barrier
    s_waitcnt lgkmcnt(7)
    v_mfma_f32_32x32x16_bf16 v[32:47], v[64:67], v[224:227], v[32:47]
    ds_read_b128 v[64:67], v10 offset:49152
    v_cvt_pk_bf16_f32 v28, v28, v29
    s_waitcnt lgkmcnt(7)
    v_mfma_f32_32x32x16_bf16 v[48:63], v[68:71], v[224:227], v[48:63]
    ds_read_b128 v[68:71], v10 offset:53248
    v_lshlrev_b32 v140, 16, v28
    s_waitcnt lgkmcnt(7)
    v_mfma_f32_32x32x16_bf16 v[32:47], v[72:75], v[228:231], v[32:47]
    ds_read_b128 v[72:75], v11 offset:49152
    v_and_b32 v141, 0xffff0000, v28
    s_waitcnt lgkmcnt(7)
    v_mfma_f32_32x32x16_bf16 v[48:63], v[76:79], v[228:231], v[48:63]
    ds_read_b128 v[76:79], v11 offset:53248
    v_sub_f32 v28, 1.0, v126
    s_waitcnt lgkmcnt(7)
    v_mfma_f32_32x32x16_bf16 v[32:47], v[80:83], v[232:235], v[32:47]
    ds_read_b128 v[80:83], v12 offset:49152
    v_sub_f32 v29, 1.0, v127
    s_waitcnt lgkmcnt(7)
    v_mfma_f32_32x32x16_bf16 v[48:63], v[84:87], v[232:235], v[48:63]
    ds_read_b128 v[84:87], v12 offset:53248
    v_cvt_pk_bf16_f32 v28, v28, v29
    s_waitcnt lgkmcnt(7)
    v_mfma_f32_32x32x16_bf16 v[32:47], v[88:91], v[236:239], v[32:47]
    ds_read_b128 v[88:91], v13 offset:49152
    v_lshlrev_b32 v142, 16, v28
    s_waitcnt lgkmcnt(7)
    v_mfma_f32_32x32x16_bf16 v[48:63], v[92:95], v[236:239], v[48:63]
    ds_read_b128 v[92:95], v13 offset:53248
    v_and_b32 v143, 0xffff0000, v28
    s_waitcnt lgkmcnt(7)
    v_mfma_f32_32x32x16_bf16 v[32:47], v[64:67], v[240:243], v[32:47]
    s_waitcnt lgkmcnt(6)
    v_mfma_f32_32x32x16_bf16 v[48:63], v[68:71], v[240:243], v[48:63]
    s_waitcnt lgkmcnt(5)
    v_mfma_f32_32x32x16_bf16 v[32:47], v[72:75], v[244:247], v[32:47]
    s_waitcnt vmcnt(0)
    v_lshlrev_b32 v28, 16, v20
    v_and_b32 v29, 0xffff0000, v20
    v_mul_f32 v28, v28, v112
    v_mul_f32 v29, v29, v113
    v_cvt_pk_bf16_f32 v28, v28, v29
    v_lshlrev_b32 v112, 16, v28
    s_waitcnt lgkmcnt(4)
    v_mfma_f32_32x32x16_bf16 v[48:63], v[76:79], v[244:247], v[48:63]
    v_and_b32 v113, 0xffff0000, v28
    v_lshlrev_b32 v28, 16, v21
    v_and_b32 v29, 0xffff0000, v21
    v_mul_f32 v28, v28, v114
    v_mul_f32 v29, v29, v115
    v_cvt_pk_bf16_f32 v28, v28, v29
    s_waitcnt lgkmcnt(3)
    v_mfma_f32_32x32x16_bf16 v[32:47], v[80:83], v[248:251], v[32:47]
    v_lshlrev_b32 v114, 16, v28
    v_and_b32 v115, 0xffff0000, v28
    v_lshlrev_b32 v28, 16, v22
    v_and_b32 v29, 0xffff0000, v22
    v_mul_f32 v28, v28, v116
    v_mul_f32 v29, v29, v117
    s_waitcnt lgkmcnt(2)
    v_mfma_f32_32x32x16_bf16 v[48:63], v[84:87], v[248:251], v[48:63]
    v_cvt_pk_bf16_f32 v28, v28, v29
    v_lshlrev_b32 v116, 16, v28
    v_and_b32 v117, 0xffff0000, v28
    v_lshlrev_b32 v28, 16, v23
    v_and_b32 v29, 0xffff0000, v23
    v_mul_f32 v28, v28, v118
    s_waitcnt lgkmcnt(1)
    v_mfma_f32_32x32x16_bf16 v[32:47], v[88:91], v[252:255], v[32:47]
    v_mul_f32 v29, v29, v119
    v_cvt_pk_bf16_f32 v28, v28, v29
    v_lshlrev_b32 v118, 16, v28
    v_and_b32 v119, 0xffff0000, v28
    v_lshlrev_b32 v28, 16, v24
    v_and_b32 v29, 0xffff0000, v24
    s_waitcnt lgkmcnt(0)
    v_mfma_f32_32x32x16_bf16 v[48:63], v[92:95], v[252:255], v[48:63]
    v_mul_f32 v28, v28, v120
    v_mul_f32 v29, v29, v121
    v_cvt_pk_bf16_f32 v28, v28, v29
    v_lshlrev_b32 v120, 16, v28
    v_and_b32 v121, 0xffff0000, v28
    v_lshlrev_b32 v28, 16, v25
    v_and_b32 v29, 0xffff0000, v25
    v_mul_f32 v28, v28, v122
    v_mul_f32 v29, v29, v123
    v_cvt_pk_bf16_f32 v28, v28, v29
    v_lshlrev_b32 v122, 16, v28
    v_and_b32 v123, 0xffff0000, v28
    v_lshlrev_b32 v28, 16, v26
    v_and_b32 v29, 0xffff0000, v26
    v_mul_f32 v28, v28, v124
    v_mul_f32 v29, v29, v125
    v_cvt_pk_bf16_f32 v28, v28, v29
    v_lshlrev_b32 v124, 16, v28
    v_and_b32 v125, 0xffff0000, v28
    v_lshlrev_b32 v28, 16, v27
    v_and_b32 v29, 0xffff0000, v27
    v_mul_f32 v28, v28, v126
    v_mul_f32 v29, v29, v127
    v_cvt_pk_bf16_f32 v28, v28, v29
    v_lshlrev_b32 v126, 16, v28
    v_and_b32 v127, 0xffff0000, v28
    s_cmp_eq_u32 s60, 0
    s_cbranch_scc1 L_g13
L_g12:
    global_load_dword v19, v18, s[46:47] sc1
    s_waitcnt vmcnt(0)
    v_cmp_ne_u32 vcc, 3, v19
    s_add_u32 s69, s69, 1
    s_cmp_lt_u32 s69, 0x400000
    s_cbranch_vccz L_g24
    s_sleep 1
    s_cbranch_scc1 L_g12
L_g24:
    global_load_dwordx4 v[20:23], v16, s[46:47] sc1
    global_load_dwordx4 v[24:27], v16, s[46:47] offset:16 sc1
    ds_read_b128 v[112:115], v17 offset:0
    ds_read_b128 v[116:119], v17 offset:16
    ds_read_b128 v[120:123], v17 offset:32
    ds_read_b128 v[124:127], v17 offset:48
    s_waitcnt vmcnt(0) lgkmcnt(0)
    v_lshlrev_b32 v28, 16, v20
    v_and_b32 v29, 0xffff0000, v20
    v_mul_f32 v28, v28, v112
    v_mul_f32 v29, v29, v113
    v_cvt_pk_bf16_f32 v28, v28, v29
    v_lshlrev_b32 v112, 16, v28
    v_and_b32 v113, 0xffff0000, v28
    v_lshlrev_b32 v28, 16, v21
    v_and_b32 v29, 0xffff0000, v21
    v_mul_f32 v28, v28, v114
    v_mul_f32 v29, v29, v115
    v_cvt_pk_bf16_f32 v28, v28, v29
    v_lshlrev_b32 v114, 16, v28
    v_and_b32 v115, 0xffff0000, v28
    v_lshlrev_b32 v28, 16, v22
    v_and_b32 v29, 0xffff0000, v22
    v_mul_f32 v28, v28, v116
    v_mul_f32 v29, v29, v117
    v_cvt_pk_bf16_f32 v28, v28, v29
    v_lshlrev_b32 v116, 16, v28
    v_and_b32 v117, 0xffff0000, v28
    v_lshlrev_b32 v28, 16, v23
    v_and_b32 v29, 0xffff0000, v23
    v_mul_f32 v28, v28, v118
    v_mul_f32 v29, v29, v119
    v_cvt_pk_bf16_f32 v28, v28, v29
    v_lshlrev_b32 v118, 16, v28
    v_and_b32 v119, 0xffff0000, v28
    v_lshlrev_b32 v28, 16, v24
    v_and_b32 v29, 0xffff0000, v24
    v_mul_f32 v28, v28, v120
    v_mul_f32 v29, v29, v121
    v_cvt_pk_bf16_f32 v28, v28, v29
    v_lshlrev_b32 v120, 16, v28
    v_and_b32 v121, 0xffff0000, v28
    v_lshlrev_b32 v28, 16, v25
    v_and_b32 v29, 0xffff0000, v25
    v_mul_f32 v28, v28, v122
    v_mul_f32 v29, v29, v123
    v_cvt_pk_bf16_f32 v28, v28, v29
    v_lshlrev_b32 v122, 16, v28
    v_and_b32 v123, 0xffff0000, v28
    v_lshlrev_b32 v28, 16, v26
    v_and_b32 v29, 0xffff0000, v26
    v_mul_f32 v28, v28, v124
    v_mul_f32 v29, v29, v125
    v_cvt_pk_bf16_f32 v28, v28, v29
    v_lshlrev_b32 v124, 16, v28
    v_and_b32 v125, 0xffff0000, v28
    v_lshlrev_b32 v28, 16, v27
    v_and_b32 v29, 0xffff0000, v27
    v_mul_f32 v28, v28, v126
    v_mul_f32 v29, v29, v127
    v_cvt_pk_bf16_f32 v28, v28, v29
    v_lshlrev_b32 v126, 16, v28
    v_and_b32 v127, 0xffff0000, v28
L_g13:
    s_mov_b32 s56, s42
    s_mov_b32 s57, s43
    s_mov_b32 s58, 4194304
    s_mov_b32 s59, 0x00020000
    s_lshl_b32 s3, s50, 12
    v_lshl_add_u32 v4, v1, 4, s3
    s_xor_b32 s3, s3, 4096
    v_lshl_add_u32 v5, v1, 4, s3
    s_cmp_eq_u32 s62, 0
    s_nop 3
    s_cbranch_scc1 L_g14
    ds_write_b128 v4, v[32:35] offset:0
    ds_write_b128 v4, v[36:39] offset:1024
    ds_write_b128 v4, v[40:43] offset:2048
    ds_write_b128 v4, v[44:47] offset:3072
    s_branch L_g15
L_g14:
    ds_write_b128 v4, v[48:51] offset:0
    ds_write_b128 v4, v[52:55] offset:1024
    ds_write_b128 v4, v[56:59] offset:2048
    ds_write_b128 v4, v[60:63] offset:3072
    s_waitcnt lgkmcnt(0)
    v_mov_b32 v48, v32
    v_mov_b32 v49, v33
    v_mov_b32 v50, v34
    v_mov_b32 v51, v35
    v_mov_b32 v52, v36
    v_mov_b32 v53, v37
    v_mov_b32 v54, v38
    v_mov_b32 v55, v39
    v_mov_b32 v56, v40
    v_mov_b32 v57, v41
    v_mov_b32 v58, v42
    v_mov_b32 v59, v43
    v_mov_b32 v60, v44
    v_mov_b32 v61, v45
    v_mov_b32 v62, v46
    v_mov_b32 v63, v47
L_g15:
    s_waitcnt lgkmcnt(0)
    s_barrier
    ds_read_b128 v[32:35], v5 offset:0
    ds_read_b128 v[36:39], v5 offset:1024
    ds_read_b128 v[40:43], v5 offset:2048
    ds_read_b128 v[44:47], v5 offset:3072
    v_fma_f32 v48, 2.0, v48, v96
    v_fma_f32 v49, 2.0, v49, v97
    v_fma_f32 v50, 2.0, v50, v98
    v_fma_f32 v51, 2.0, v51, v99
    v_fma_f32 v52, 2.0, v52, v100
    v_fma_f32 v53, 2.0, v53, v101
    v_fma_f32 v54, 2.0, v54, v102
    v_fma_f32 v55, 2.0, v55, v103
    v_fma_f32 v56, 2.0, v56, v104
    v_fma_f32 v57, 2.0, v57, v105
    v_fma_f32 v58, 2.0, v58, v106
    v_fma_f32 v59, 2.0, v59, v107
    v_fma_f32 v60, 2.0, v60, v108
    v_fma_f32 v61, 2.0, v61, v109
    v_fma_f32 v62, 2.0, v62, v110
    v_fma_f32 v63, 2.0, v63, v111
    s_lshl_b32 s3, s50, 12
    s_add_u32 s3, s3, 16384
    v_lshlrev_b32 v6, 2, v2
    v_lshl_add_u32 v6, v3, 11, v6
    v_add_u32 v6, s3, v6
    v_lshl_add_u32 v7, v1, 4, s3
    s_lshl_b32 s3, s62, 5
    s_add_u32 s3, s3, s49
    s_lshl_b32 s3, s3, 11
    s_lshl_b32 s4, s48, 2
    s_add_u32 s3, s3, s4
    v_lshrrev_b32 v8, 3, v1
    v_lshlrev_b32 v8, 11, v8
    v_and_b32 v9, 7, v1
    v_lshl_add_u32 v8, v9, 4, v8
    v_add_u32 v8, s3, v8
    s_waitcnt lgkmcnt(0)
    v_fma_f32 v32, 2.0, v32, v48
    v_fma_f32 v32, v128, v32, v112
    ds_write_b32 v6, v32 offset:0
    v_fma_f32 v33, 2.0, v33, v49
    v_fma_f32 v33, v129, v33, v113
    ds_write_b32 v6, v33 offset:128
    v_fma_f32 v34, 2.0, v34, v50
    v_fma_f32 v34, v130, v34, v114
    ds_write_b32 v6, v34 offset:256
    v_fma_f32 v35, 2.0, v35, v51
    v_fma_f32 v35, v131, v35, v115
    ds_write_b32 v6, v35 offset:384
    v_fma_f32 v36, 2.0, v36, v52
    v_fma_f32 v36, v132, v36, v116
    ds_write_b32 v6, v36 offset:512
    v_fma_f32 v37, 2.0, v37, v53
    v_fma_f32 v37, v133, v37, v117
    ds_write_b32 v6, v37 offset:640
    v_fma_f32 v38, 2.0, v38, v54
    v_fma_f32 v38, v134, v38, v118
    ds_write_b32 v6, v38 offset:768
    v_fma_f32 v39, 2.0, v39, v55
    v_fma_f32 v39, v135, v39, v119
    ds_write_b32 v6, v39 offset:896
    ds_read_b128 v[64:67], v7 offset:0
    ds_read_b128 v[72:75], v7 offset:2048
    v_fma_f32 v40, 2.0, v40, v56
    v_fma_f32 v40, v136, v40, v120
    ds_write_b32 v6, v40 offset:1024
    v_fma_f32 v41, 2.0, v41, v57
    v_fma_f32 v41, v137, v41, v121
    ds_write_b32 v6, v41 offset:1152
    v_fma_f32 v42, 2.0, v42, v58
    v_fma_f32 v42, v138, v42, v122
    ds_write_b32 v6, v42 offset:1280
    v_fma_f32 v43, 2.0, v43, v59
    v_fma_f32 v43, v139, v43, v123
    ds_write_b32 v6, v43 offset:1408
    s_waitcnt lgkmcnt(4)
    s_mov_b32 s3, 0
    buffer_store_dwordx4 v[64:67], v8, s[56:59], s3 offen sc1
    s_mov_b32 s3, 32768
    buffer_store_dwordx4 v[72:75], v8, s[56:59], s3 offen sc1
    v_fma_f32 v44, 2.0, v44, v60
    v_fma_f32 v44, v140, v44, v124
    ds_write_b32 v6, v44 offset:1536
    v_fma_f32 v45, 2.0, v45, v61
    v_fma_f32 v45, v141, v45, v125
    ds_write_b32 v6, v45 offset:1664
    v_fma_f32 v46, 2.0, v46, v62
    v_fma_f32 v46, v142, v46, v126
    ds_write_b32 v6, v46 offset:1792
    v_fma_f32 v47, 2.0, v47, v63
    v_fma_f32 v47, v143, v47, v127
    ds_write_b32 v6, v47 offset:1920
    ds_read_b128 v[68:71], v7 offset:1024
    ds_read_b128 v[76:79], v7 offset:3072
    s_waitcnt lgkmcnt(0)
    s_mov_b32 s3, 16384
    buffer_store_dwordx4 v[68:71], v8, s[56:59], s3 offen sc1
    s_mov_b32 s3, 49152
    buffer_store_dwordx4 v[76:79], v8, s[56:59], s3 offen sc1
    s_endpgm
L_conv:
    s_and_b32 s51, s2, 7
    s_lshl_b32 s51, s51, 6
    s_lshr_b32 s3, s2, 3
    s_lshl_b32 s3, s3, 1
    s_add_u32 s51, s51, s3
    s_lshr_b32 s52, s50, 1
    s_and_b32 s53, s50, 1
    s_add_u32 s54, s51, s52
    s_lshl_b32 s3, s51, 8
    v_lshl_add_u32 v4, v0, 1, s3
    s_and_b32 s60, s2, 7
    s_lshr_b32 s61, s2, 3
    s_lshl_b32 s3, s61, 16
    s_lshl_b32 s4, s60, 7
    s_add_u32 s3, s3, s4
    s_lshl_b32 s4, s50, 14
    s_add_u32 s3, s3, s4
    v_lshrrev_b32 v5, 3, v1
    v_lshlrev_b32 v5, 10, v5
    v_and_b32 v6, 7, v1
    v_lshl_add_u32 v5, v6, 4, v5
    v_add_u32 v5, s3, v5
    v_add_u32 v6, 7168, v5
    s_lshl_b32 s62, s60, 12
    s_add_u32 s62, s62, 0x600000
    s_lshl_b32 s3, s61, 7
    s_add_u32 s63, s62, s3
    s_mul_i32 s55, s50, 8704
    s_lshl_b32 s3, s54, 1
    v_mov_b32 v10, s3
    s_cmp_lt_u32 s2, 16
    s_cselect_b32 s68, s50, 9
    s_cmp_eq_u32 s61, 1
    s_cselect_b32 s3, s50, 1
    s_cmp_eq_u32 s3, 0
    s_cselect_b32 s68, 9, s68
    s_waitcnt lgkmcnt(0)
    s_mov_b32 s56, s8
    s_mov_b32 s57, s9
    s_mov_b32 s58, 2097152
    s_mov_b32 s59, 0x00020000
    global_load_ushort v20, v4, s[10:11]
    global_load_ushort v21, v4, s[12:13]
    global_load_ushort v22, v4, s[14:15]
    global_load_ushort v23, v4, s[16:17]
    global_load_ushort v24, v10, s[18:19]
    global_load_ushort v127, v10, s[20:21]
    s_lshl_b32 s3, s50, 11
    s_add_u32 m0, s3, 34816
    s_nop 0
    buffer_load_dwordx4 v5, s[56:59], 0 offen lds
    buffer_load_dwordx4 v6, s[56:59], 0 offen offset:1024 lds
    s_cmp_gt_u32 s68, 1
    s_cbranch_scc1 L_c1
    s_sub_u32 s4, 0, s68
    v_mov_b32 v12, s4
    v_mov_b32 v13, s4
    v_mov_b32 v14, s4
    v_mov_b32 v15, s4
    s_mov_b32 s3, s62
    s_cmp_eq_u32 s68, 0
    s_cbranch_scc1 L_c60
    s_lshl_b32 s4, s2, 11
    s_add_u32 s4, s4, 6324224
    v_lshl_add_u32 v11, v1, 4, s4
    global_store_dwordx4 v11, v[12:15], s[46:47] sc1
    global_store_dwordx4 v11, v[12:15], s[46:47] offset:1024 sc1
    s_lshl_b32 s3, s2, 12
    s_add_u32 s3, s3, 6356992
L_c60:
    v_lshl_add_u32 v11, v1, 4, s3
    global_store_dwordx4 v11, v[12:15], s[46:47] offset:0 sc1
    global_store_dwordx4 v11, v[12:15], s[46:47] offset:1024 sc1
    global_store_dwordx4 v11, v[12:15], s[46:47] offset:2048 sc1
    global_store_dwordx4 v11, v[12:15], s[46:47] offset:3072 sc1
L_c1:
    v_lshl_add_u32 v4, v1, 2, s55
    v_mul_u32_u24 v5, 272, v2
    v_lshl_add_u32 v5, v3, 4, v5
    v_add_u32 v5, s55, v5
    v_mov_b32 v6, 0
    v_lshlrev_b32 v7, 2, v0
    v_add_u32 v7, 69632, v7
    ds_write_b32 v7, v6
    v_lshrrev_b32 v8, 4, v1
    v_lshlrev_b32 v9, 10, v8
    v_bfe_u32 v11, v1, 2, 2
    v_lshl_add_u32 v9, v11, 7, v9
    v_and_b32 v11, 3, v1
    v_lshl_add_u32 v9, v11, 3, v9
    s_lshl_b32 s3, s50, 5
    s_add_u32 s3, s3, 34816
    v_add_u32 v9, s3, v9
    s_lshl_b32 s3, s60, 18
    s_lshl_b32 s4, s50, 11
    s_add_u32 s3, s3, s4
    s_lshl_b32 s4, s61, 13
    s_add_u32 s3, s3, s4
    s_add_u32 s3, s3, 10485760
    v_and_b32 v11, 15, v1
    v_lshlrev_b32 v11, 7, v11
    v_lshl_add_u32 v11, v8, 4, v11
    v_add_u32 v11, s3, v11
    s_lshl_b32 s3, s60, 5
    v_mov_b32 v122, s3
    s_waitcnt vmcnt(8)
    s_cmp_eq_u32 s68, 1
    s_cbranch_scc1 L_c9
    s_waitcnt vmcnt(6)
    s_cmp_eq_u32 s68, 0
    s_cbranch_scc1 L_c9
    s_waitcnt vmcnt(2)
L_c9:
    v_lshlrev_b32 v20, 16, v20
    v_lshlrev_b32 v21, 16, v21
    v_lshlrev_b32 v22, 16, v22
    v_lshlrev_b32 v23, 16, v23
    v_lshlrev_b32 v24, 16, v24
    v_lshlrev_b32 v127, 16, v127
    v_mul_f32 v20, 1069066811, v20
    v_mul_f32 v24, 1069066811, v24
    v_exp_f32 v20, v20
    v_exp_f32 v24, v24
    v_cvt_pk_bf16_f32 v20, v20, v20
    v_and_b32 v20, 0xffff0000, v20
    v_cvt_pk_bf16_f32 v24, v24, v24
    v_and_b32 v24, 0xffff0000, v24
    v_mul_f32 v20, v20, v24
    v_mul_f32 v21, v21, v24
    v_mul_f32 v22, v22, v24
    v_mul_f32 v23, v23, v24
    v_mul_f32 v20, 3216550459, v20
    v_mul_f32 v21, 0.15915494, v21
    v_max_f32 v25, abs(v22), abs(v23)
    v_mul_f32 v18, 0x41000000, v20
    v_mul_f32 v19, 0x41000000, v21
    v_exp_f32 v18, v18
    v_fract_f32 v19, v19
    v_cos_f32 v26, v19
    v_sin_f32 v27, v19
    v_mul_f32 v26, v26, v18
    v_mul_f32 v27, v27, v18
    v_max_f32_dpp v25, v25, v25 row_ror:1 row_mask:0xf bank_mask:0xf
    s_nop 1
    v_max_f32_dpp v25, v25, v25 row_ror:2 row_mask:0xf bank_mask:0xf
    s_nop 1
    v_max_f32_dpp v25, v25, v25 row_ror:4 row_mask:0xf bank_mask:0xf
    s_nop 1
    v_max_f32_dpp v25, v25, v25 row_ror:8 row_mask:0xf bank_mask:0xf
    s_nop 0
    v_readlane_b32 s4, v25, 0
    v_readlane_b32 s5, v25, 16
    v_readlane_b32 s6, v25, 32
    v_readlane_b32 s7, v25, 48
    s_max_u32 s4, s4, s5
    s_max_u32 s6, s6, s7
    s_max_u32 s4, s4, s6
    s_and_b32 s4, s4, 0x7f800000
    s_max_u32 s4, s4, 0x0d800000
    s_sub_u32 s5, 0x84000000, s4
    s_sub_u32 s69, s4, 0x09800000
    v_mul_f32 v18, v27, v27
    v_mul_f32 v19, v26, v27
    v_fma_f32 v29, v27, v26, v19
    v_fma_f32 v28, v26, v26, -v18
    v_mov_b32 v30, 0x44800000
    v_mov_b32 v31, 0
    v_mul_f32 v32, 0x44800000, v26
    v_mul_f32 v33, 0x44800000, v27
    s_waitcnt vmcnt(6)
    s_cmp_eq_u32 s68, 1
    s_cbranch_scc1 L_c8
    s_waitcnt vmcnt(4)
    s_cmp_eq_u32 s68, 0
    s_cbranch_scc1 L_c8
    s_waitcnt vmcnt(0)
L_c8:
    s_barrier
    ds_read_b64_tr_b16 v[40:41], v9
    ds_read_b64_tr_b16 v[42:43], v9 offset:512
    ds_read_b64_tr_b16 v[44:45], v9 offset:4096
    ds_read_b64_tr_b16 v[46:47], v9 offset:4608
    s_waitcnt lgkmcnt(2)
    global_store_dwordx4 v11, v[40:43], s[46:47] sc1
    s_waitcnt lgkmcnt(0)
    global_store_dwordx4 v11, v[44:47], s[46:47] offset:64 sc1
    s_cmp_lg_u32 s68, 0
    s_cbranch_scc1 L_c40
    s_waitcnt vmcnt(2)
    s_lshl_b32 s3, s2, 5
    v_mov_b32 v124, s3
    v_mov_b32 v125, 1
    s_mov_b64 exec, 1
    global_store_dword v124, v125, s[44:45] offset:0 sc1
    s_mov_b64 exec, -1
L_c40:
    v_cvt_pk_f16_f32 v16, v30, v31
    ds_write_b32 v4, v16 offset:0
    v_cvt_pk_f16_f32 v17, v32, v33
    ds_write_b32 v4, v17 offset:272
    v_mul_f32 v18, v31, v29
    v_mul_f32 v19, v30, v29
    v_fma_f32 v31, v31, v28, v19
    v_fma_f32 v30, v30, v28, -v18
    v_mul_f32 v14, v33, v29
    v_mul_f32 v15, v32, v29
    v_fma_f32 v33, v33, v28, v15
    v_fma_f32 v32, v32, v28, -v14
    v_cvt_pk_f16_f32 v16, v30, v31
    ds_write_b32 v4, v16 offset:544
    v_cvt_pk_f16_f32 v17, v32, v33
    ds_write_b32 v4, v17 offset:816
    v_mul_f32 v18, v31, v29
    v_mul_f32 v19, v30, v29
    v_fma_f32 v31, v31, v28, v19
    v_fma_f32 v30, v30, v28, -v18
    v_mul_f32 v14, v33, v29
    v_mul_f32 v15, v32, v29
    v_fma_f32 v33, v33, v28, v15
    v_fma_f32 v32, v32, v28, -v14
    v_cvt_pk_f16_f32 v16, v30, v31
    ds_write_b32 v4, v16 offset:1088
    v_cvt_pk_f16_f32 v17, v32, v33
    ds_write_b32 v4, v17 offset:1360
    v_mul_f32 v18, v31, v29
    v_mul_f32 v19, v30, v29
    v_fma_f32 v31, v31, v28, v19
    v_fma_f32 v30, v30, v28, -v18
    v_mul_f32 v14, v33, v29
    v_mul_f32 v15, v32, v29
    v_fma_f32 v33, v33, v28, v15
    v_fma_f32 v32, v32, v28, -v14
    v_cvt_pk_f16_f32 v16, v30, v31
    ds_write_b32 v4, v16 offset:1632
    v_cvt_pk_f16_f32 v17, v32, v33
    ds_write_b32 v4, v17 offset:1904
    v_mul_f32 v18, v31, v29
    v_mul_f32 v19, v30, v29
    v_fma_f32 v31, v31, v28, v19
    v_fma_f32 v30, v30, v28, -v18
    v_mul_f32 v14, v33, v29
    v_mul_f32 v15, v32, v29
    v_fma_f32 v33, v33, v28, v15
    v_fma_f32 v32, v32, v28, -v14
    v_cvt_pk_f16_f32 v16, v30, v31
    ds_write_b32 v4, v16 offset:2176
    v_cvt_pk_f16_f32 v17, v32, v33
    ds_write_b32 v4, v17 offset:2448
    v_mul_f32 v18, v31, v29
    v_mul_f32 v19, v30, v29
    v_fma_f32 v31, v31, v28, v19
    v_fma_f32 v30, v30, v28, -v18
    v_mul_f32 v14, v33, v29
    v_mul_f32 v15, v32, v29
    v_fma_f32 v33, v33, v28, v15
    v_fma_f32 v32, v32, v28, -v14
    v_cvt_pk_f16_f32 v16, v30, v31
    ds_write_b32 v4, v16 offset:2720
    v_cvt_pk_f16_f32 v17, v32, v33
    ds_write_b32 v4, v17 offset:2992
    v_mul_f32 v18, v31, v29
    v_mul_f32 v19, v30, v29
    v_fma_f32 v31, v31, v28, v19
    v_fma_f32 v30, v30, v28, -v18
    v_mul_f32 v14, v33, v29
    v_mul_f32 v15, v32, v29
    v_fma_f32 v33, v33, v28, v15
    v_fma_f32 v32, v32, v28, -v14
    v_cvt_pk_f16_f32 v16, v30, v31
    ds_write_b32 v4, v16 offset:3264
    v_cvt_pk_f16_f32 v17, v32, v33
    ds_write_b32 v4, v17 offset:3536
    v_mul_f32 v18, v31, v29
    v_mul_f32 v19, v30, v29
    v_fma_f32 v31, v31, v28, v19
    v_fma_f32 v30, v30, v28, -v18
    v_mul_f32 v14, v33, v29
    v_mul_f32 v15, v32, v29
    v_fma_f32 v33, v33, v28, v15
    v_fma_f32 v32, v32, v28, -v14
    v_cvt_pk_f16_f32 v16, v30, v31
    ds_write_b32 v4, v16 offset:3808
    v_cvt_pk_f16_f32 v17, v32, v33
    ds_write_b32 v4, v17 offset:4080
    v_mul_f32 v18, v31, v29
    v_mul_f32 v19, v30, v29
    v_fma_f32 v31, v31, v28, v19
    v_fma_f32 v30, v30, v28, -v18
    v_mul_f32 v14, v33, v29
    v_mul_f32 v15, v32, v29
    v_fma_f32 v33, v33, v28, v15
    v_fma_f32 v32, v32, v28, -v14
    v_cvt_pk_f16_f32 v16, v30, v31
    ds_write_b32 v4, v16 offset:4352
    v_cvt_pk_f16_f32 v17, v32, v33
    ds_write_b32 v4, v17 offset:4624
    v_mul_f32 v18, v31, v29
    v_mul_f32 v19, v30, v29
    v_fma_f32 v31, v31, v28, v19
    v_fma_f32 v30, v30, v28, -v18
    v_mul_f32 v14, v33, v29
    v_mul_f32 v15, v32, v29
    v_fma_f32 v33, v33, v28, v15
    v_fma_f32 v32, v32, v28, -v14
    v_cvt_pk_f16_f32 v16, v30, v31
    ds_write_b32 v4, v16 offset:4896
    v_cvt_pk_f16_f32 v17, v32, v33
    ds_write_b32 v4, v17 offset:5168
    v_mul_f32 v18, v31, v29
    v_mul_f32 v19, v30, v29
    v_fma_f32 v31, v31, v28, v19
    v_fma_f32 v30, v30, v28, -v18
    v_mul_f32 v14, v33, v29
    v_mul_f32 v15, v32, v29
    v_fma_f32 v33, v33, v28, v15
    v_fma_f32 v32, v32, v28, -v14
    v_cvt_pk_f16_f32 v16, v30, v31
    ds_write_b32 v4, v16 offset:5440
    v_cvt_pk_f16_f32 v17, v32, v33
    ds_write_b32 v4, v17 offset:5712
    v_mul_f32 v18, v31, v29
    v_mul_f32 v19, v30, v29
    v_fma_f32 v31, v31, v28, v19
    v_fma_f32 v30, v30, v28, -v18
    v_mul_f32 v14, v33, v29
    v_mul_f32 v15, v32, v29
    v_fma_f32 v33, v33, v28, v15
    v_fma_f32 v32, v32, v28, -v14
    v_cvt_pk_f16_f32 v16, v30, v31
    ds_write_b32 v4, v16 offset:5984
    v_cvt_pk_f16_f32 v17, v32, v33
    ds_write_b32 v4, v17 offset:6256
    v_mul_f32 v18, v31, v29
    v_mul_f32 v19, v30, v29
    v_fma_f32 v31, v31, v28, v19
    v_fma_f32 v30, v30, v28, -v18
    v_mul_f32 v14, v33, v29
    v_mul_f32 v15, v32, v29
    v_fma_f32 v33, v33, v28, v15
    v_fma_f32 v32, v32, v28, -v14
    v_cvt_pk_f16_f32 v16, v30, v31
    ds_write_b32 v4, v16 offset:6528
    v_cvt_pk_f16_f32 v17, v32, v33
    ds_write_b32 v4, v17 offset:6800
    v_mul_f32 v18, v31, v29
    v_mul_f32 v19, v30, v29
    v_fma_f32 v31, v31, v28, v19
    v_fma_f32 v30, v30, v28, -v18
    v_mul_f32 v14, v33, v29
    v_mul_f32 v15, v32, v29
    v_fma_f32 v33, v33, v28, v15
    v_fma_f32 v32, v32, v28, -v14
    v_cvt_pk_f16_f32 v16, v30, v31
    ds_write_b32 v4, v16 offset:7072
    v_cvt_pk_f16_f32 v17, v32, v33
    ds_write_b32 v4, v17 offset:7344
    v_mul_f32 v18, v31, v29
    v_mul_f32 v19, v30, v29
    v_fma_f32 v31, v31, v28, v19
    v_fma_f32 v30, v30, v28, -v18
    v_mul_f32 v14, v33, v29
    v_mul_f32 v15, v32, v29
    v_fma_f32 v33, v33, v28, v15
    v_fma_f32 v32, v32, v28, -v14
    v_cvt_pk_f16_f32 v16, v30, v31
    ds_write_b32 v4, v16 offset:7616
    v_cvt_pk_f16_f32 v17, v32, v33
    ds_write_b32 v4, v17 offset:7888
    v_mul_f32 v18, v31, v29
    v_mul_f32 v19, v30, v29
    v_fma_f32 v31, v31, v28, v19
    v_fma_f32 v30, v30, v28, -v18
    v_mul_f32 v14, v33, v29
    v_mul_f32 v15, v32, v29
    v_fma_f32 v33, v33, v28, v15
    v_fma_f32 v32, v32, v28, -v14
    v_cvt_pk_f16_f32 v16, v30, v31
    ds_write_b32 v4, v16 offset:8160
    v_cvt_pk_f16_f32 v17, v32, v33
    ds_write_b32 v4, v17 offset:8432
    s_cmp_lg_u32 s50, 0
    s_cbranch_scc1 L_c20
    global_load_dword v126, v122, s[44:45] sc1
L_c20:
    ds_read_b128 v[64:67], v5 offset:0
    ds_read_b128 v[68:71], v5 offset:32
    ds_read_b128 v[72:75], v5 offset:64
    ds_read_b128 v[76:79], v5 offset:96
    ds_read_b128 v[80:83], v5 offset:128
    ds_read_b128 v[84:87], v5 offset:160
    ds_read_b128 v[88:91], v5 offset:192
    ds_read_b128 v[92:95], v5 offset:224
    v_mul_f32 v18, 1.0, v20
    v_mul_f32 v19, 1.0, v21
    v_exp_f32 v18, v18
    v_fract_f32 v19, v19
    v_cos_f32 v28, v19
    v_sin_f32 v29, v19
    v_mul_f32 v28, v28, v18
    v_mul_f32 v29, v29, v18
    v_mul_f32 v18, 0x43800000, v20
    v_mul_f32 v19, 0x43800000, v21
    v_exp_f32 v18, v18
    v_fract_f32 v19, v19
    v_cos_f32 v34, v19
    v_sin_f32 v35, v19
    v_mul_f32 v34, v34, v18
    v_mul_f32 v35, v35, v18
    v_mul_f32 v22, s5, v22
    v_mul_f32 v23, s5, v23
    v_mul_f32 v18, v29, v29
    v_mul_f32 v19, v28, v29
    v_fma_f32 v37, v29, v28, v19
    v_fma_f32 v36, v28, v28, -v18
    v_mul_f32 v18, v37, v37
    v_mul_f32 v19, v36, v37
    v_fma_f32 v39, v37, v36, v19
    v_fma_f32 v38, v36, v36, -v18
    v_mul_f32 v14, v23, v35
    v_mul_f32 v15, v22, v35
    v_fma_f32 v41, v23, v34, v15
    v_fma_f32 v40, v22, v34, -v14
    v_cvt_pk_f16_f32 v16, v22, -v23
    ds_write_b32 v4, v16 offset:0
    v_cvt_pk_f16_f32 v16, v40, -v41
    ds_write_b32 v4, v16 offset:1088
    v_mul_f32 v14, v23, v29
    v_mul_f32 v15, v22, v29
    v_fma_f32 v23, v23, v28, v15
    v_fma_f32 v22, v22, v28, -v14
    v_cvt_pk_f16_f32 v17, v22, -v23
    ds_write_b32 v4, v17 offset:272
    s_waitcnt vmcnt(0)
    s_barrier
    s_mov_b32 s49, s50
    s_cmp_lg_u32 s49, 0
    s_cbranch_scc1 L_c2
    s_waitcnt vmcnt(0)
    v_cmp_ne_u32 vcc, 1, v126
    s_nop 1
    s_cbranch_vccz L_c2a
    global_load_dword v126, v122, s[44:45] sc1
    s_branch L_c2
L_c2a:
    s_mov_b32 s49, 1
    v_mov_b32 v124, s63
    v_mov_b32 v125, 1
    s_mov_b64 exec, 1
    global_store_dword v124, v125, s[46:47] sc1
    s_mov_b64 exec, -1
L_c2:
    v_mul_f32 v18, v41, v37
    v_mul_f32 v19, v40, v37
    v_fma_f32 v43, v41, v36, v19
    v_fma_f32 v42, v40, v36, -v18
    v_cvt_pk_f16_f32 v16, v42, -v43
    ds_write_b32 v4, v16 offset:1360
    v_mul_f32 v14, v23, v29
    v_mul_f32 v15, v22, v29
    v_fma_f32 v23, v23, v28, v15
    v_fma_f32 v22, v22, v28, -v14
    v_cvt_pk_f16_f32 v17, v22, -v23
    ds_write_b32 v4, v17 offset:544
    v_mul_f32 v18, v43, v37
    v_mul_f32 v19, v42, v37
    v_fma_f32 v43, v43, v36, v19
    v_fma_f32 v42, v42, v36, -v18
    v_cvt_pk_f16_f32 v16, v42, -v43
    ds_write_b32 v4, v16 offset:1632
    v_mul_f32 v14, v23, v29
    v_mul_f32 v15, v22, v29
    v_fma_f32 v23, v23, v28, v15
    v_fma_f32 v22, v22, v28, -v14
    v_cvt_pk_f16_f32 v17, v22, -v23
    ds_write_b32 v4, v17 offset:816
    v_mul_f32 v18, v43, v37
    v_mul_f32 v19, v42, v37
    v_fma_f32 v43, v43, v36, v19
    v_fma_f32 v42, v42, v36, -v18
    v_cvt_pk_f16_f32 v16, v42, -v43
    ds_write_b32 v4, v16 offset:1904
    v_mul_f32 v14, v23, v29
    v_mul_f32 v15, v22, v29
    v_fma_f32 v23, v23, v28, v15
    v_fma_f32 v22, v22, v28, -v14
    v_cvt_pk_f16_f32 v17, v22, -v23
    ds_write_b32 v4, v17 offset:2176
    v_mul_f32 v18, v43, v37
    v_mul_f32 v19, v42, v37
    v_fma_f32 v43, v43, v36, v19
    v_fma_f32 v42, v42, v36, -v18
    v_cvt_pk_f16_f32 v16, v42, -v43
    ds_write_b32 v4, v16 offset:3264
    v_mul_f32 v14, v23, v29
    v_mul_f32 v15, v22, v29
    v_fma_f32 v23, v23, v28, v15
    v_fma_f32 v22, v22, v28, -v14
    v_cvt_pk_f16_f32 v17, v22, -v23
    ds_write_b32 v4, v17 offset:2448
    v_mul_f32 v18, v41, v35
    v_mul_f32 v19, v40, v35
    v_fma_f32 v41, v41, v34, v19
    v_fma_f32 v40, v40, v34, -v18
    v_cvt_pk_f16_f32 v16, v40, -v41
    ds_write_b32 v4, v16 offset:3536
    v_mul_f32 v14, v23, v29
    v_mul_f32 v15, v22, v29
    v_fma_f32 v23, v23, v28, v15
    v_fma_f32 v22, v22, v28, -v14
    v_cvt_pk_f16_f32 v17, v22, -v23
    ds_write_b32 v4, v17 offset:2720
    v_mul_f32 v18, v41, v39
    v_mul_f32 v19, v40, v39
    v_fma_f32 v43, v41, v38, v19
    v_fma_f32 v42, v40, v38, -v18
    v_cvt_pk_f16_f32 v16, v42, -v43
    ds_write_b32 v4, v16 offset:3808
    v_mul_f32 v14, v23, v29
    v_mul_f32 v15, v22, v29
    v_fma_f32 v23, v23, v28, v15
    v_fma_f32 v22, v22, v28, -v14
    v_cvt_pk_f16_f32 v17, v22, -v23
    ds_write_b32 v4, v17 offset:2992
    v_mul_f32 v18, v43, v39
    v_mul_f32 v19, v42, v39
    v_fma_f32 v43, v43, v38, v19
    v_fma_f32 v42, v42, v38, -v18
    v_cvt_pk_f16_f32 v16, v42, -v43
    ds_write_b32 v4, v16 offset:4080
    v_mul_f32 v18, v41, v35
    v_mul_f32 v19, v40, v35
    v_fma_f32 v41, v41, v34, v19
    v_fma_f32 v40, v40, v34, -v18
    v_cvt_pk_f16_f32 v16, v40, -v41
    ds_write_b32 v4, v16 offset:5440
    v_mul_f32 v18, v41, v39
    v_mul_f32 v19, v40, v39
    v_fma_f32 v43, v41, v38, v19
    v_fma_f32 v42, v40, v38, -v18
    v_cvt_pk_f16_f32 v16, v42, -v43
    ds_write_b32 v4, v16 offset:5712
    v_mul_f32 v18, v43, v39
    v_mul_f32 v19, v42, v39
    v_fma_f32 v43, v43, v38, v19
    v_fma_f32 v42, v42, v38, -v18
    v_cvt_pk_f16_f32 v16, v42, -v43
    ds_write_b32 v4, v16 offset:5984
    v_mul_f32 v18, v41, v35
    v_mul_f32 v19, v40, v35
    v_fma_f32 v41, v41, v34, v19
    v_fma_f32 v40, v40, v34, -v18
    v_cvt_pk_f16_f32 v16, v40, -v41
    ds_write_b32 v4, v16 offset:4352
    v_mul_f32 v18, v41, v27
    v_mul_f32 v19, v40, v27
    v_fma_f32 v43, v41, v26, v19
    v_fma_f32 v42, v40, v26, -v18
    v_cvt_pk_f16_f32 v16, v42, -v43
    ds_write_b32 v4, v16 offset:4624
    s_cmp_lg_u32 s49, 0
    s_cbranch_scc1 L_c51
    s_waitcnt vmcnt(0)
    v_cmp_ne_u32 vcc, 1, v126
    s_nop 1
    s_cbranch_vccz L_c51a
    global_load_dword v126, v122, s[44:45] sc1
    s_branch L_c51
L_c51a:
    s_mov_b32 s49, 1
    v_mov_b32 v124, s63
    v_mov_b32 v125, 1
    s_mov_b64 exec, 1
    global_store_dword v124, v125, s[46:47] sc1
    s_mov_b64 exec, -1
L_c51:
    v_mul_f32 v18, v41, v35
    v_mul_f32 v19, v40, v35
    v_fma_f32 v41, v41, v34, v19
    v_fma_f32 v40, v40, v34, -v18
    v_cvt_pk_f16_f32 v16, v40, -v41
    ds_write_b32 v4, v16 offset:4896
    v_mul_f32 v18, v41, v27
    v_mul_f32 v19, v40, v27
    v_fma_f32 v43, v41, v26, v19
    v_fma_f32 v42, v40, v26, -v18
    v_cvt_pk_f16_f32 v16, v42, -v43
    ds_write_b32 v4, v16 offset:5168
    v_mul_f32 v18, v41, v35
    v_mul_f32 v19, v40, v35
    v_fma_f32 v41, v41, v34, v19
    v_fma_f32 v40, v40, v34, -v18
    v_cvt_pk_f16_f32 v16, v40, -v41
    ds_write_b32 v4, v16 offset:6528
    v_mul_f32 v18, v41, v27
    v_mul_f32 v19, v40, v27
    v_fma_f32 v43, v41, v26, v19
    v_fma_f32 v42, v40, v26, -v18
    v_cvt_pk_f16_f32 v16, v42, -v43
    ds_write_b32 v4, v16 offset:6800
    v_mul_f32 v18, v41, v35
    v_mul_f32 v19, v40, v35
    v_fma_f32 v41, v41, v34, v19
    v_fma_f32 v40, v40, v34, -v18
    v_cvt_pk_f16_f32 v16, v40, -v41
    ds_write_b32 v4, v16 offset:7072
    v_mul_f32 v18, v41, v27
    v_mul_f32 v19, v40, v27
    v_fma_f32 v43, v41, v26, v19
    v_fma_f32 v42, v40, v26, -v18
    v_cvt_pk_f16_f32 v16, v42, -v43
    ds_write_b32 v4, v16 offset:7344
    v_lshl_add_u32 v123, v2, 7, s62
    v_mov_b32 v121, 0
    s_cmp_lg_u32 s50, 0
    s_cbranch_scc1 L_c31
    s_cmp_eq_u32 s49, 0
    s_cbranch_scc1 L_c31
    global_load_dword v121, v123, s[46:47] sc1
L_c31:
    ds_read_b128 v[16:19], v5 offset:0
    ds_read_b128 v[20:23], v5 offset:32
    ds_read_b128 v[24:27], v5 offset:64
    ds_read_b128 v[28:31], v5 offset:96
    ds_read_b128 v[32:35], v5 offset:128
    ds_read_b128 v[36:39], v5 offset:160
    ds_read_b128 v[40:43], v5 offset:192
    ds_read_b128 v[44:47], v5 offset:224
    s_waitcnt lgkmcnt(7)
    v_mfma_f32_32x32x16_f16 v[48:63], v[16:19], v[64:67], 0
    s_waitcnt lgkmcnt(6)
    v_mfma_f32_32x32x16_f16 v[48:63], v[20:23], v[68:71], v[48:63]
    s_waitcnt lgkmcnt(5)
    v_mfma_f32_32x32x16_f16 v[48:63], v[24:27], v[72:75], v[48:63]
    s_waitcnt lgkmcnt(4)
    v_mfma_f32_32x32x16_f16 v[48:63], v[28:31], v[76:79], v[48:63]
    s_waitcnt lgkmcnt(3)
    v_mfma_f32_32x32x16_f16 v[48:63], v[32:35], v[80:83], v[48:63]
    s_waitcnt lgkmcnt(2)
    v_mfma_f32_32x32x16_f16 v[48:63], v[36:39], v[84:87], v[48:63]
    s_waitcnt lgkmcnt(1)
    v_mfma_f32_32x32x16_f16 v[48:63], v[40:43], v[88:91], v[48:63]
    s_waitcnt lgkmcnt(0)
    v_mfma_f32_32x32x16_f16 v[48:63], v[44:47], v[92:95], v[48:63]
    v_lshl_add_u32 v4, v1, 4, s55
    s_xor_b32 s3, s50, 1
    s_mul_i32 s3, s3, 8704
    v_lshl_add_u32 v5, v1, 4, s3
    s_mul_i32 s3, s53, 128
    s_add_u32 s3, s3, 4096
    s_add_u32 s3, s3, s55
    v_lshl_add_u32 v7, v1, 2, s3
    ds_write_b32 v7, v6
    s_mul_i32 s4, s53, 8
    s_sub_u32 s3, s3, s4
    s_add_u32 s3, s3, 248
    v_lshl_add_u32 v7, v2, 4, s3
    v_mul_f32 v48, s69, v48
    v_mul_f32 v49, s69, v49
    v_mul_f32 v50, s69, v50
    v_mul_f32 v51, s69, v51
    v_mul_f32 v52, s69, v52
    v_mul_f32 v53, s69, v53
    v_mul_f32 v54, s69, v54
    v_mul_f32 v55, s69, v55
    v_mul_f32 v56, s69, v56
    v_mul_f32 v57, s69, v57
    v_mul_f32 v58, s69, v58
    v_mul_f32 v59, s69, v59
    v_mul_f32 v60, s69, v60
    v_mul_f32 v61, s69, v61
    v_mul_f32 v62, s69, v62
    v_mul_f32 v63, s69, v63
    ds_write_b128 v4, v[48:51] offset:0
    ds_write_b128 v4, v[52:55] offset:1024
    ds_write_b128 v4, v[56:59] offset:2048
    ds_write_b128 v4, v[60:63] offset:3072
    s_mov_b32 s7, 0
    s_cmp_lg_u32 s49, 0
    s_cbranch_scc1 L_c11
L_c10:
    global_load_dword v126, v122, s[44:45] sc1
    s_waitcnt vmcnt(0)
    v_cmp_ne_u32 vcc, 1, v126
    s_add_u32 s7, s7, 1
    s_cmp_lt_u32 s7, 0x400000
    s_cbranch_vccz L_c12
    s_sleep 2
    s_cbranch_scc1 L_c10
L_c12:
    v_mov_b32 v124, s63
    v_mov_b32 v125, 1
    s_mov_b64 exec, 1
    global_store_dword v124, v125, s[46:47] sc1
    s_mov_b64 exec, -1
L_c11:
    v_lshl_add_u32 v123, v2, 7, s62
    s_lshl_b32 s3, s60, 18
    s_lshl_b32 s4, s61, 8
    s_add_u32 s3, s3, s4
    s_add_u32 s3, s3, 10485760
    s_add_u32 s64, s46, s3
    s_addc_u32 s65, s47, 0
    s_mov_b32 s66, 262144
    s_mov_b32 s67, 0x00020000
    v_lshrrev_b32 v8, 3, v0
    v_lshlrev_b32 v8, 13, v8
    v_and_b32 v9, 7, v0
    v_lshl_add_u32 v8, v9, 4, v8
    v_cmp_eq_u32 vcc, 0, v9
    v_subrev_u32 v9, 8, v8
    v_subrev_u32 v11, 8072, v8
    v_cndmask_b32 v9, v9, v11, vcc
    s_cmp_lg_u32 s50, 0
    s_cbranch_scc1 L_c6
L_c5:
    s_waitcnt vmcnt(0)
    v_cmp_eq_u32 vcc, 0, v121
    s_add_u32 s7, s7, 1
    s_cmp_lt_u32 s7, 0x400000
    s_cbranch_vccz L_c6
    global_load_dword v121, v123, s[46:47] sc1
    s_cbranch_scc1 L_c5
L_c6:
    s_waitcnt lgkmcnt(0)
    s_barrier
    buffer_load_dwordx2 v[96:97], v9, s[64:67], 0 offen sc1
    buffer_load_dwordx4 v[98:101], v8, s[64:67], 0 offen sc1
    buffer_load_dwordx2 v[102:103], v9, s[64:67], 0 offen offset:128 sc1
    buffer_load_dwordx4 v[104:107], v8, s[64:67], 0 offen offset:128 sc1
    ds_read_b128 v[16:19], v5 offset:0
    ds_read_b128 v[20:23], v5 offset:1024
    ds_read_b128 v[24:27], v5 offset:2048
    ds_read_b128 v[28:31], v5 offset:3072
    s_mul_i32 s3, s52, 17408
    s_mul_i32 s4, s53, 4352
    s_sub_u32 s3, s3, s4
    s_add_u32 s3, s3, 34816
    v_lshrrev_b32 v9, 2, v2
    v_mul_u32_u24 v10, 272, v2
    v_lshl_add_u32 v10, v3, 4, v10
    v_add_u32 v10, s3, v10
    v_add_u32 v14, 5440, v10
    s_lshl_b32 s4, s53, 2
    v_subrev_u32 v12, 0, v10
    v_and_b32 v13, 255, v12
    v_add_u32 v13, 69632, v13
    s_add_u32 s5, s4, 0
    v_cmp_gt_u32 vcc, s5, v9
    s_nop 1
    v_cndmask_b32 v108, v12, v13, vcc
    v_subrev_u32 v12, 1088, v10
    v_and_b32 v13, 255, v12
    v_add_u32 v13, 69632, v13
    s_add_u32 s5, s4, 1
    v_cmp_gt_u32 vcc, s5, v9
    s_nop 1
    v_cndmask_b32 v109, v12, v13, vcc
    v_subrev_u32 v12, 2176, v10
    v_and_b32 v13, 255, v12
    v_add_u32 v13, 69632, v13
    s_add_u32 s5, s4, 2
    v_cmp_gt_u32 vcc, s5, v9
    s_nop 1
    v_cndmask_b32 v110, v12, v13, vcc
    v_subrev_u32 v12, 3264, v10
    v_and_b32 v13, 255, v12
    v_add_u32 v13, 69632, v13
    s_add_u32 s5, s4, 3
    v_cmp_gt_u32 vcc, s5, v9
    s_nop 1
    v_cndmask_b32 v111, v12, v13, vcc
    s_mul_i32 s3, s52, 17408
    s_lshl_b32 s4, s53, 10
    s_add_u32 s3, s3, s4
    s_add_u32 s3, s3, 4096
    v_and_b32 v9, 1, v2
    v_cmp_eq_u32 vcc, 1, v9
    v_mul_u32_u24 v9, 8832, v9
    v_lshrrev_b32 v12, 1, v2
    v_add_u32 v12, v12, v3
    v_lshl_add_u32 v15, v12, 4, v9
    v_add_u32 v15, s3, v15
    s_waitcnt lgkmcnt(0)
    v_add_f32 v48, v48, v16
    v_add_f32 v49, v49, v17
    v_add_f32 v50, v50, v18
    v_add_f32 v51, v51, v19
    v_add_f32 v52, v52, v20
    v_add_f32 v53, v53, v21
    v_add_f32 v54, v54, v22
    v_add_f32 v55, v55, v23
    v_add_f32 v56, v56, v24
    v_add_f32 v57, v57, v25
    v_add_f32 v58, v58, v26
    v_add_f32 v59, v59, v27
    v_add_f32 v60, v60, v28
    v_add_f32 v61, v61, v29
    v_add_f32 v62, v62, v30
    v_add_f32 v63, v63, v31
    s_mov_b32 exec_hi, 0
    v_cvt_pk_bf16_f32 v16, v48, v49
    v_cvt_pk_bf16_f32 v17, v50, v51
    v_cvt_pk_bf16_f32 v18, v52, v53
    v_cvt_pk_bf16_f32 v19, v54, v55
    ds_write_b64 v7, v[16:17] offset:0
    ds_write_b64 v7, v[18:19] offset:8
    v_cndmask_b32 v12, v56, v57, vcc
    v_cvt_pk_bf16_f32 v20, v56, v56
    v_cvt_pk_bf16_f32 v21, v56, v56
    v_cvt_pk_bf16_f32 v22, v12, v57
    v_cvt_pk_bf16_f32 v23, v57, v57
    ds_write_b64 v7, v[20:21] offset:2048
    ds_write_b64 v7, v[22:23] offset:2056
    v_cndmask_b32 v12, v58, v59, vcc
    v_cvt_pk_bf16_f32 v24, v58, v58
    v_cvt_pk_bf16_f32 v25, v58, v58
    v_cvt_pk_bf16_f32 v26, v12, v59
    v_cvt_pk_bf16_f32 v27, v59, v59
    ds_write_b64 v7, v[24:25] offset:2560
    ds_write_b64 v7, v[26:27] offset:2568
    v_cndmask_b32 v12, v60, v61, vcc
    v_cvt_pk_bf16_f32 v28, v60, v60
    v_cvt_pk_bf16_f32 v29, v60, v60
    v_cvt_pk_bf16_f32 v30, v12, v61
    v_cvt_pk_bf16_f32 v31, v61, v61
    ds_write_b64 v7, v[28:29] offset:3072
    ds_write_b64 v7, v[30:31] offset:3080
    v_cndmask_b32 v12, v62, v63, vcc
    v_cvt_pk_bf16_f32 v32, v62, v62
    v_cvt_pk_bf16_f32 v33, v62, v62
    v_cvt_pk_bf16_f32 v34, v12, v63
    v_cvt_pk_bf16_f32 v35, v63, v63
    ds_write_b64 v7, v[32:33] offset:3584
    ds_write_b64 v7, v[34:35] offset:3592
    s_mov_b32 exec_hi, -1
    s_mov_b32 exec_lo, 0
    v_cvt_pk_bf16_f32 v36, v48, v48
    v_cvt_pk_bf16_f32 v37, v49, v50
    v_cvt_pk_bf16_f32 v38, v50, v50
    v_cvt_pk_bf16_f32 v39, v51, v52
    ds_write_b64 v7, v[36:37] offset:512
    ds_write_b64 v7, v[38:39] offset:520
    v_cvt_pk_bf16_f32 v40, v53, v53
    v_cvt_pk_bf16_f32 v41, v53, v54
    v_cvt_pk_bf16_f32 v42, v54, v54
    v_cvt_pk_bf16_f32 v43, v55, v55
    ds_write_b64 v7, v[40:41] offset:1024
    ds_write_b64 v7, v[42:43] offset:1032
    v_cvt_pk_bf16_f32 v44, v56, v56
    v_cvt_pk_bf16_f32 v45, v56, v57
    v_cvt_pk_bf16_f32 v46, v57, v57
    v_cvt_pk_bf16_f32 v47, v58, v58
    ds_write_b64 v7, v[44:45] offset:1536
    ds_write_b64 v7, v[46:47] offset:1544
    s_mov_b32 exec_lo, -1
    v_lshrrev_b32 v8, 4, v0
    v_mul_u32_u24 v8, 1088, v8
    v_and_b32 v9, 15, v0
    v_lshlrev_b32 v9, 4, v9
    v_sub_u32 v8, v8, v9
    v_add_u32 v8, 35056, v8
    s_mov_b32 s4, 0x01000302
    s_mov_b32 s5, 0x07060100
    s_waitcnt vmcnt(0)
    v_perm_b32 v64, v99, v100, s5
    v_perm_b32 v65, v98, v99, s5
    v_perm_b32 v66, v97, v98, s5
    v_perm_b32 v67, v96, v97, s5
    ds_write_b128 v8, v[64:67] offset:0
    v_perm_b32 v68, v100, v100, s4
    v_perm_b32 v69, v99, v99, s4
    v_perm_b32 v70, v98, v98, s4
    v_perm_b32 v71, v97, v97, s4
    ds_write_b128 v8, v[68:71] offset:272
    v_perm_b32 v72, v100, v101, s5
    v_perm_b32 v73, v99, v100, s5
    v_perm_b32 v74, v98, v99, s5
    v_perm_b32 v75, v97, v98, s5
    ds_write_b128 v8, v[72:75] offset:544
    v_perm_b32 v76, v101, v101, s4
    v_perm_b32 v77, v100, v100, s4
    v_perm_b32 v78, v99, v99, s4
    v_perm_b32 v79, v98, v98, s4
    ds_write_b128 v8, v[76:79] offset:816
    v_perm_b32 v80, v105, v106, s5
    v_perm_b32 v81, v104, v105, s5
    v_perm_b32 v82, v103, v104, s5
    v_perm_b32 v83, v102, v103, s5
    ds_write_b128 v8, v[80:83] offset:17408
    v_perm_b32 v84, v106, v106, s4
    v_perm_b32 v85, v105, v105, s4
    v_perm_b32 v86, v104, v104, s4
    v_perm_b32 v87, v103, v103, s4
    ds_write_b128 v8, v[84:87] offset:17680
    v_perm_b32 v88, v106, v107, s5
    v_perm_b32 v89, v105, v106, s5
    v_perm_b32 v90, v104, v105, s5
    v_perm_b32 v91, v103, v104, s5
    ds_write_b128 v8, v[88:91] offset:17952
    v_perm_b32 v92, v107, v107, s4
    v_perm_b32 v93, v106, v106, s4
    v_perm_b32 v94, v105, v105, s4
    v_perm_b32 v95, v104, v104, s4
    ds_write_b128 v8, v[92:95] offset:18224
    s_waitcnt lgkmcnt(0)
    s_barrier
    s_mul_i32 s3, s52, 17408
    s_mul_i32 s4, s53, 8704
    s_add_u32 s3, s3, s4
    s_add_u32 s3, s3, 35880
    v_mul_u32_u24 v8, 1088, v3
    v_lshlrev_b32 v9, 3, v2
    v_sub_u32 v8, v8, v9
    v_add_u32 v8, s3, v8
    ds_read_b64 v[96:97], v8 offset:0
    ds_read_b64 v[98:99], v8 offset:2176
    ds_read_b64 v[100:101], v8 offset:4352
    ds_read_b64 v[102:103], v8 offset:6528
    s_lshl_b32 s3, s54, 12
    s_lshl_b32 s4, s53, 11
    s_add_u32 s3, s3, s4
    s_add_u32 s3, s3, 4194304
    v_lshl_add_u32 v9, v1, 3, s3
    v_and_b32 v12, 1, v1
    v_cmp_eq_u32 vcc, 1, v12
    v_mul_u32_u24 v12, 504, v12
    v_add_u32 v9, v9, v12
    ds_read_b128 v[48:51], v108 offset:0
    ds_read_b128 v[56:59], v15 offset:0
    ds_read_b128 v[52:55], v14 offset:3264
    ds_read_b128 v[60:63], v15 offset:2048
    ds_read_b128 v[64:67], v108 offset:32
    ds_read_b128 v[72:75], v15 offset:32
    ds_read_b128 v[68:71], v14 offset:3296
    ds_read_b128 v[76:79], v15 offset:2080
    s_waitcnt lgkmcnt(4)
    v_mfma_f32_32x32x16_bf16 v[16:31], v[48:51], v[56:59], 0
    ds_read_b128 v[80:83], v108 offset:64
    ds_read_b128 v[88:91], v15 offset:64
    v_mfma_f32_32x32x16_bf16 v[32:47], v[52:55], v[56:59], 0
    ds_read_b128 v[84:87], v14 offset:3328
    v_and_b32 v128, 0xffff0000, v97
    v_lshlrev_b32 v129, 16, v97
    v_mfma_f32_32x32x16_bf16 v[32:47], v[48:51], v[60:63], v[32:47]
    ds_read_b128 v[92:95], v15 offset:2112
    s_waitcnt lgkmcnt(4)
    v_mfma_f32_32x32x16_bf16 v[16:31], v[64:67], v[72:75], v[16:31]
    ds_read_b128 v[48:51], v108 offset:96
    ds_read_b128 v[56:59], v15 offset:96
    v_mfma_f32_32x32x16_bf16 v[32:47], v[68:71], v[72:75], v[32:47]
    ds_read_b128 v[52:55], v14 offset:3360
    v_and_b32 v130, 0xffff0000, v96
    v_lshlrev_b32 v131, 16, v96
    v_mfma_f32_32x32x16_bf16 v[32:47], v[64:67], v[76:79], v[32:47]
    ds_read_b128 v[60:63], v15 offset:2144
    s_waitcnt lgkmcnt(4)
    v_mfma_f32_32x32x16_bf16 v[16:31], v[80:83], v[88:91], v[16:31]
    ds_read_b128 v[64:67], v108 offset:128
    ds_read_b128 v[72:75], v15 offset:128
    v_mfma_f32_32x32x16_bf16 v[32:47], v[84:87], v[88:91], v[32:47]
    ds_read_b128 v[68:71], v14 offset:3392
    v_mul_f32 v128, v127, v128
    v_mul_f32 v129, v127, v129
    v_mfma_f32_32x32x16_bf16 v[32:47], v[80:83], v[92:95], v[32:47]
    ds_read_b128 v[76:79], v15 offset:2176
    s_waitcnt lgkmcnt(4)
    v_mfma_f32_32x32x16_bf16 v[16:31], v[48:51], v[56:59], v[16:31]
    ds_read_b128 v[80:83], v108 offset:160
    ds_read_b128 v[88:91], v15 offset:160
    v_mfma_f32_32x32x16_bf16 v[32:47], v[52:55], v[56:59], v[32:47]
    ds_read_b128 v[84:87], v14 offset:3424
    v_mul_f32 v130, v127, v130
    v_mul_f32 v131, v127, v131
    v_mfma_f32_32x32x16_bf16 v[32:47], v[48:51], v[60:63], v[32:47]
    ds_read_b128 v[92:95], v15 offset:2208
    s_waitcnt lgkmcnt(4)
    v_mfma_f32_32x32x16_bf16 v[16:31], v[64:67], v[72:75], v[16:31]
    ds_read_b128 v[48:51], v108 offset:192
    ds_read_b128 v[56:59], v15 offset:192
    v_mfma_f32_32x32x16_bf16 v[32:47], v[68:71], v[72:75], v[32:47]
    ds_read_b128 v[52:55], v14 offset:3456
    v_cvt_pk_bf16_f32 v129, v128, v129
    v_cvt_pk_bf16_f32 v131, v130, v131
    v_mfma_f32_32x32x16_bf16 v[32:47], v[64:67], v[76:79], v[32:47]
    ds_read_b128 v[60:63], v15 offset:2240
    s_waitcnt lgkmcnt(4)
    v_mfma_f32_32x32x16_bf16 v[16:31], v[80:83], v[88:91], v[16:31]
    ds_read_b128 v[64:67], v108 offset:224
    ds_read_b128 v[72:75], v15 offset:224
    v_mfma_f32_32x32x16_bf16 v[32:47], v[84:87], v[88:91], v[32:47]
    ds_read_b128 v[68:71], v14 offset:3488
    v_lshlrev_b32 v128, 16, v129
    v_lshlrev_b32 v130, 16, v131
    v_mfma_f32_32x32x16_bf16 v[32:47], v[80:83], v[92:95], v[32:47]
    ds_read_b128 v[76:79], v15 offset:2272
    s_waitcnt lgkmcnt(4)
    v_mfma_f32_32x32x16_bf16 v[16:31], v[48:51], v[56:59], v[16:31]
    ds_read_b128 v[80:83], v109 offset:0
    ds_read_b128 v[88:91], v15 offset:256
    v_mfma_f32_32x32x16_bf16 v[32:47], v[52:55], v[56:59], v[32:47]
    ds_read_b128 v[84:87], v14 offset:2176
    v_and_b32 v129, 0xffff0000, v129
    v_and_b32 v131, 0xffff0000, v131
    v_mfma_f32_32x32x16_bf16 v[32:47], v[48:51], v[60:63], v[32:47]
    ds_read_b128 v[92:95], v15 offset:2304
    s_waitcnt lgkmcnt(4)
    v_mfma_f32_32x32x16_bf16 v[16:31], v[64:67], v[72:75], v[16:31]
    ds_read_b128 v[48:51], v109 offset:32
    ds_read_b128 v[56:59], v15 offset:288
    v_mfma_f32_32x32x16_bf16 v[32:47], v[68:71], v[72:75], v[32:47]
    ds_read_b128 v[52:55], v14 offset:2208
    v_and_b32 v132, 0xffff0000, v99
    v_lshlrev_b32 v133, 16, v99
    v_mfma_f32_32x32x16_bf16 v[32:47], v[64:67], v[76:79], v[32:47]
    ds_read_b128 v[60:63], v15 offset:2336
    s_waitcnt lgkmcnt(4)
    v_mfma_f32_32x32x16_bf16 v[16:31], v[80:83], v[88:91], v[16:31]
    ds_read_b128 v[64:67], v109 offset:64
    ds_read_b128 v[72:75], v15 offset:320
    v_mfma_f32_32x32x16_bf16 v[32:47], v[84:87], v[88:91], v[32:47]
    ds_read_b128 v[68:71], v14 offset:2240
    v_and_b32 v134, 0xffff0000, v98
    v_lshlrev_b32 v135, 16, v98
    v_mfma_f32_32x32x16_bf16 v[32:47], v[80:83], v[92:95], v[32:47]
    ds_read_b128 v[76:79], v15 offset:2368
    s_waitcnt lgkmcnt(4)
    v_mfma_f32_32x32x16_bf16 v[16:31], v[48:51], v[56:59], v[16:31]
    ds_read_b128 v[80:83], v109 offset:96
    ds_read_b128 v[88:91], v15 offset:352
    v_mfma_f32_32x32x16_bf16 v[32:47], v[52:55], v[56:59], v[32:47]
    ds_read_b128 v[84:87], v14 offset:2272
    v_mul_f32 v132, v127, v132
    v_mul_f32 v133, v127, v133
    v_mfma_f32_32x32x16_bf16 v[32:47], v[48:51], v[60:63], v[32:47]
    ds_read_b128 v[92:95], v15 offset:2400
    s_waitcnt lgkmcnt(4)
    v_mfma_f32_32x32x16_bf16 v[16:31], v[64:67], v[72:75], v[16:31]
    ds_read_b128 v[48:51], v109 offset:128
    ds_read_b128 v[56:59], v15 offset:384
    v_mfma_f32_32x32x16_bf16 v[32:47], v[68:71], v[72:75], v[32:47]
    ds_read_b128 v[52:55], v14 offset:2304
    v_mul_f32 v134, v127, v134
    v_mul_f32 v135, v127, v135
    v_mfma_f32_32x32x16_bf16 v[32:47], v[64:67], v[76:79], v[32:47]
    ds_read_b128 v[60:63], v15 offset:2432
    s_waitcnt lgkmcnt(4)
    v_mfma_f32_32x32x16_bf16 v[16:31], v[80:83], v[88:91], v[16:31]
    ds_read_b128 v[64:67], v109 offset:160
    ds_read_b128 v[72:75], v15 offset:416
    v_mfma_f32_32x32x16_bf16 v[32:47], v[84:87], v[88:91], v[32:47]
    ds_read_b128 v[68:71], v14 offset:2336
    v_cvt_pk_bf16_f32 v133, v132, v133
    v_cvt_pk_bf16_f32 v135, v134, v135
    v_mfma_f32_32x32x16_bf16 v[32:47], v[80:83], v[92:95], v[32:47]
    ds_read_b128 v[76:79], v15 offset:2464
    s_waitcnt lgkmcnt(4)
    v_mfma_f32_32x32x16_bf16 v[16:31], v[48:51], v[56:59], v[16:31]
    ds_read_b128 v[80:83], v109 offset:192
    ds_read_b128 v[88:91], v15 offset:448
    v_mfma_f32_32x32x16_bf16 v[32:47], v[52:55], v[56:59], v[32:47]
    ds_read_b128 v[84:87], v14 offset:2368
    v_lshlrev_b32 v132, 16, v133
    v_lshlrev_b32 v134, 16, v135
    v_mfma_f32_32x32x16_bf16 v[32:47], v[48:51], v[60:63], v[32:47]
    ds_read_b128 v[92:95], v15 offset:2496
    s_waitcnt lgkmcnt(4)
    v_mfma_f32_32x32x16_bf16 v[16:31], v[64:67], v[72:75], v[16:31]
    ds_read_b128 v[48:51], v109 offset:224
    ds_read_b128 v[56:59], v15 offset:480
    v_mfma_f32_32x32x16_bf16 v[32:47], v[68:71], v[72:75], v[32:47]
    ds_read_b128 v[52:55], v14 offset:2400
    v_and_b32 v133, 0xffff0000, v133
    v_and_b32 v135, 0xffff0000, v135
    v_mfma_f32_32x32x16_bf16 v[32:47], v[64:67], v[76:79], v[32:47]
    ds_read_b128 v[60:63], v15 offset:2528
    s_waitcnt lgkmcnt(4)
    v_mfma_f32_32x32x16_bf16 v[16:31], v[80:83], v[88:91], v[16:31]
    ds_read_b128 v[64:67], v110 offset:0
    ds_read_b128 v[72:75], v15 offset:512
    v_mfma_f32_32x32x16_bf16 v[32:47], v[84:87], v[88:91], v[32:47]
    ds_read_b128 v[68:71], v14 offset:1088
    v_and_b32 v136, 0xffff0000, v101
    v_lshlrev_b32 v137, 16, v101
    v_mfma_f32_32x32x16_bf16 v[32:47], v[80:83], v[92:95], v[32:47]
    ds_read_b128 v[76:79], v15 offset:2560
    s_waitcnt lgkmcnt(4)
    v_mfma_f32_32x32x16_bf16 v[16:31], v[48:51], v[56:59], v[16:31]
    ds_read_b128 v[80:83], v110 offset:32
    ds_read_b128 v[88:91], v15 offset:544
    v_mfma_f32_32x32x16_bf16 v[32:47], v[52:55], v[56:59], v[32:47]
    ds_read_b128 v[84:87], v14 offset:1120
    v_and_b32 v138, 0xffff0000, v100
    v_lshlrev_b32 v139, 16, v100
    v_mfma_f32_32x32x16_bf16 v[32:47], v[48:51], v[60:63], v[32:47]
    ds_read_b128 v[92:95], v15 offset:2592
    s_waitcnt lgkmcnt(4)
    v_mfma_f32_32x32x16_bf16 v[16:31], v[64:67], v[72:75], v[16:31]
    ds_read_b128 v[48:51], v110 offset:64
    ds_read_b128 v[56:59], v15 offset:576
    v_mfma_f32_32x32x16_bf16 v[32:47], v[68:71], v[72:75], v[32:47]
    ds_read_b128 v[52:55], v14 offset:1152
    v_mul_f32 v136, v127, v136
    v_mul_f32 v137, v127, v137
    v_mfma_f32_32x32x16_bf16 v[32:47], v[64:67], v[76:79], v[32:47]
    ds_read_b128 v[60:63], v15 offset:2624
    s_waitcnt lgkmcnt(4)
    v_mfma_f32_32x32x16_bf16 v[16:31], v[80:83], v[88:91], v[16:31]
    ds_read_b128 v[64:67], v110 offset:96
    ds_read_b128 v[72:75], v15 offset:608
    v_mfma_f32_32x32x16_bf16 v[32:47], v[84:87], v[88:91], v[32:47]
    ds_read_b128 v[68:71], v14 offset:1184
    v_mul_f32 v138, v127, v138
    v_mul_f32 v139, v127, v139
    v_mfma_f32_32x32x16_bf16 v[32:47], v[80:83], v[92:95], v[32:47]
    ds_read_b128 v[76:79], v15 offset:2656
    s_waitcnt lgkmcnt(4)
    v_mfma_f32_32x32x16_bf16 v[16:31], v[48:51], v[56:59], v[16:31]
    ds_read_b128 v[80:83], v110 offset:128
    ds_read_b128 v[88:91], v15 offset:640
    v_mfma_f32_32x32x16_bf16 v[32:47], v[52:55], v[56:59], v[32:47]
    ds_read_b128 v[84:87], v14 offset:1216
    v_cvt_pk_bf16_f32 v137, v136, v137
    v_cvt_pk_bf16_f32 v139, v138, v139
    v_mfma_f32_32x32x16_bf16 v[32:47], v[48:51], v[60:63], v[32:47]
    ds_read_b128 v[92:95], v15 offset:2688
    s_waitcnt lgkmcnt(4)
    v_mfma_f32_32x32x16_bf16 v[16:31], v[64:67], v[72:75], v[16:31]
    ds_read_b128 v[48:51], v110 offset:160
    ds_read_b128 v[56:59], v15 offset:672
    v_mfma_f32_32x32x16_bf16 v[32:47], v[68:71], v[72:75], v[32:47]
    ds_read_b128 v[52:55], v14 offset:1248
    v_lshlrev_b32 v136, 16, v137
    v_lshlrev_b32 v138, 16, v139
    v_mfma_f32_32x32x16_bf16 v[32:47], v[64:67], v[76:79], v[32:47]
    ds_read_b128 v[60:63], v15 offset:2720
    s_waitcnt lgkmcnt(4)
    v_mfma_f32_32x32x16_bf16 v[16:31], v[80:83], v[88:91], v[16:31]
    ds_read_b128 v[64:67], v110 offset:192
    ds_read_b128 v[72:75], v15 offset:704
    v_mfma_f32_32x32x16_bf16 v[32:47], v[84:87], v[88:91], v[32:47]
    ds_read_b128 v[68:71], v14 offset:1280
    v_and_b32 v137, 0xffff0000, v137
    v_and_b32 v139, 0xffff0000, v139
    v_mfma_f32_32x32x16_bf16 v[32:47], v[80:83], v[92:95], v[32:47]
    ds_read_b128 v[76:79], v15 offset:2752
    s_waitcnt lgkmcnt(4)
    v_mfma_f32_32x32x16_bf16 v[16:31], v[48:51], v[56:59], v[16:31]
    ds_read_b128 v[80:83], v110 offset:224
    ds_read_b128 v[88:91], v15 offset:736
    v_mfma_f32_32x32x16_bf16 v[32:47], v[52:55], v[56:59], v[32:47]
    ds_read_b128 v[84:87], v14 offset:1312
    v_and_b32 v140, 0xffff0000, v103
    v_lshlrev_b32 v141, 16, v103
    v_mfma_f32_32x32x16_bf16 v[32:47], v[48:51], v[60:63], v[32:47]
    ds_read_b128 v[92:95], v15 offset:2784
    s_waitcnt lgkmcnt(4)
    v_mfma_f32_32x32x16_bf16 v[16:31], v[64:67], v[72:75], v[16:31]
    ds_read_b128 v[48:51], v111 offset:0
    ds_read_b128 v[56:59], v15 offset:768
    v_mfma_f32_32x32x16_bf16 v[32:47], v[68:71], v[72:75], v[32:47]
    ds_read_b128 v[52:55], v14 offset:0
    v_and_b32 v142, 0xffff0000, v102
    v_lshlrev_b32 v143, 16, v102
    v_mfma_f32_32x32x16_bf16 v[32:47], v[64:67], v[76:79], v[32:47]
    ds_read_b128 v[60:63], v15 offset:2816
    s_waitcnt lgkmcnt(4)
    v_mfma_f32_32x32x16_bf16 v[16:31], v[80:83], v[88:91], v[16:31]
    ds_read_b128 v[64:67], v111 offset:32
    ds_read_b128 v[72:75], v15 offset:800
    v_mfma_f32_32x32x16_bf16 v[32:47], v[84:87], v[88:91], v[32:47]
    ds_read_b128 v[68:71], v14 offset:32
    v_mul_f32 v140, v127, v140
    v_mul_f32 v141, v127, v141
    v_mfma_f32_32x32x16_bf16 v[32:47], v[80:83], v[92:95], v[32:47]
    ds_read_b128 v[76:79], v15 offset:2848
    s_waitcnt lgkmcnt(4)
    v_mfma_f32_32x32x16_bf16 v[16:31], v[48:51], v[56:59], v[16:31]
    ds_read_b128 v[80:83], v111 offset:64
    ds_read_b128 v[88:91], v15 offset:832
    v_mfma_f32_32x32x16_bf16 v[32:47], v[52:55], v[56:59], v[32:47]
    ds_read_b128 v[84:87], v14 offset:64
    v_mul_f32 v142, v127, v142
    v_mul_f32 v143, v127, v143
    v_mfma_f32_32x32x16_bf16 v[32:47], v[48:51], v[60:63], v[32:47]
    ds_read_b128 v[92:95], v15 offset:2880
    s_waitcnt lgkmcnt(4)
    v_mfma_f32_32x32x16_bf16 v[16:31], v[64:67], v[72:75], v[16:31]
    ds_read_b128 v[48:51], v111 offset:96
    ds_read_b128 v[56:59], v15 offset:864
    v_mfma_f32_32x32x16_bf16 v[32:47], v[68:71], v[72:75], v[32:47]
    ds_read_b128 v[52:55], v14 offset:96
    v_cvt_pk_bf16_f32 v141, v140, v141
    v_cvt_pk_bf16_f32 v143, v142, v143
    v_mfma_f32_32x32x16_bf16 v[32:47], v[64:67], v[76:79], v[32:47]
    ds_read_b128 v[60:63], v15 offset:2912
    s_waitcnt lgkmcnt(4)
    v_mfma_f32_32x32x16_bf16 v[16:31], v[80:83], v[88:91], v[16:31]
    ds_read_b128 v[64:67], v111 offset:128
    ds_read_b128 v[72:75], v15 offset:896
    v_mfma_f32_32x32x16_bf16 v[32:47], v[84:87], v[88:91], v[32:47]
    ds_read_b128 v[68:71], v14 offset:128
    v_lshlrev_b32 v140, 16, v141
    v_lshlrev_b32 v142, 16, v143
    v_mfma_f32_32x32x16_bf16 v[32:47], v[80:83], v[92:95], v[32:47]
    ds_read_b128 v[76:79], v15 offset:2944
    s_waitcnt lgkmcnt(4)
    v_mfma_f32_32x32x16_bf16 v[16:31], v[48:51], v[56:59], v[16:31]
    ds_read_b128 v[80:83], v111 offset:160
    ds_read_b128 v[88:91], v15 offset:928
    v_mfma_f32_32x32x16_bf16 v[32:47], v[52:55], v[56:59], v[32:47]
    ds_read_b128 v[84:87], v14 offset:160
    v_and_b32 v141, 0xffff0000, v141
    v_and_b32 v143, 0xffff0000, v143
    v_mfma_f32_32x32x16_bf16 v[32:47], v[48:51], v[60:63], v[32:47]
    ds_read_b128 v[92:95], v15 offset:2976
    s_waitcnt lgkmcnt(4)
    v_mfma_f32_32x32x16_bf16 v[16:31], v[64:67], v[72:75], v[16:31]
    ds_read_b128 v[48:51], v111 offset:192
    ds_read_b128 v[56:59], v15 offset:960
    v_mfma_f32_32x32x16_bf16 v[32:47], v[68:71], v[72:75], v[32:47]
    ds_read_b128 v[52:55], v14 offset:192
    v_mfma_f32_32x32x16_bf16 v[32:47], v[64:67], v[76:79], v[32:47]
    ds_read_b128 v[60:63], v15 offset:3008
    s_waitcnt lgkmcnt(4)
    v_mfma_f32_32x32x16_bf16 v[16:31], v[80:83], v[88:91], v[16:31]
    ds_read_b128 v[64:67], v111 offset:224
    ds_read_b128 v[72:75], v15 offset:992
    v_mfma_f32_32x32x16_bf16 v[32:47], v[84:87], v[88:91], v[32:47]
    ds_read_b128 v[68:71], v14 offset:224
    v_mfma_f32_32x32x16_bf16 v[32:47], v[80:83], v[92:95], v[32:47]
    ds_read_b128 v[76:79], v15 offset:3040
    s_waitcnt lgkmcnt(4)
    v_mfma_f32_32x32x16_bf16 v[16:31], v[48:51], v[56:59], v[16:31]
    s_nop 0
    s_nop 0
    v_mfma_f32_32x32x16_bf16 v[32:47], v[52:55], v[56:59], v[32:47]
    s_nop 0
    v_mfma_f32_32x32x16_bf16 v[32:47], v[48:51], v[60:63], v[32:47]
    s_nop 0
    s_waitcnt lgkmcnt(0)
    v_mfma_f32_32x32x16_bf16 v[16:31], v[64:67], v[72:75], v[16:31]
    s_nop 0
    s_nop 0
    v_mfma_f32_32x32x16_bf16 v[32:47], v[68:71], v[72:75], v[32:47]
    s_nop 0
    v_mfma_f32_32x32x16_bf16 v[32:47], v[64:67], v[76:79], v[32:47]
    s_nop 0
    s_cmp_eq_u32 s53, 0
    s_nop 11
    s_cbranch_scc1 L_c3
    ds_write_b128 v4, v[16:19] offset:0
    ds_write_b128 v4, v[20:23] offset:1024
    ds_write_b128 v4, v[24:27] offset:2048
    ds_write_b128 v4, v[28:31] offset:3072
    s_branch L_c4
L_c3:
    ds_write_b128 v4, v[32:35] offset:0
    ds_write_b128 v4, v[36:39] offset:1024
    ds_write_b128 v4, v[40:43] offset:2048
    ds_write_b128 v4, v[44:47] offset:3072
    s_waitcnt lgkmcnt(0)
    v_mov_b32 v32, v16
    v_mov_b32 v33, v17
    v_mov_b32 v34, v18
    v_mov_b32 v35, v19
    v_mov_b32 v36, v20
    v_mov_b32 v37, v21
    v_mov_b32 v38, v22
    v_mov_b32 v39, v23
    v_mov_b32 v40, v24
    v_mov_b32 v41, v25
    v_mov_b32 v42, v26
    v_mov_b32 v43, v27
    v_mov_b32 v44, v28
    v_mov_b32 v45, v29
    v_mov_b32 v46, v30
    v_mov_b32 v47, v31
L_c4:
    s_waitcnt lgkmcnt(0)
    s_barrier
    ds_read_b128 v[16:19], v5 offset:0
    ds_read_b128 v[20:23], v5 offset:1024
    ds_read_b128 v[24:27], v5 offset:2048
    ds_read_b128 v[28:31], v5 offset:3072
    s_waitcnt lgkmcnt(0)
    v_add_f32 v32, v32, v16
    v_add_f32 v33, v33, v17
    v_add_f32 v34, v34, v18
    v_add_f32 v35, v35, v19
    v_cvt_pk_bf16_f32 v33, v32, v33
    v_cvt_pk_bf16_f32 v35, v34, v35
    v_lshlrev_b32 v32, 16, v33
    v_lshlrev_b32 v34, 16, v35
    v_and_b32 v33, 0xffff0000, v33
    v_and_b32 v35, 0xffff0000, v35
    v_add_f32 v32, v32, v128
    v_add_f32 v33, v33, v129
    v_add_f32 v34, v34, v130
    v_add_f32 v35, v35, v131
    v_cvt_pk_bf16_f32 v32, v32, v33
    v_cvt_pk_bf16_f32 v33, v34, v35
    v_add_f32 v36, v36, v20
    v_add_f32 v37, v37, v21
    v_add_f32 v38, v38, v22
    v_add_f32 v39, v39, v23
    v_cvt_pk_bf16_f32 v37, v36, v37
    v_cvt_pk_bf16_f32 v39, v38, v39
    v_lshlrev_b32 v36, 16, v37
    v_lshlrev_b32 v38, 16, v39
    v_and_b32 v37, 0xffff0000, v37
    v_and_b32 v39, 0xffff0000, v39
    v_add_f32 v36, v36, v132
    v_add_f32 v37, v37, v133
    v_add_f32 v38, v38, v134
    v_add_f32 v39, v39, v135
    v_cvt_pk_bf16_f32 v36, v36, v37
    v_cvt_pk_bf16_f32 v37, v38, v39
    v_cndmask_b32 v52, v36, v32, vcc
    v_cndmask_b32 v53, v37, v33, vcc
    s_nop 0
    v_mov_b32_dpp v54, v52 quad_perm:[1,0,3,2] row_mask:0xf bank_mask:0xf
    v_mov_b32_dpp v55, v53 quad_perm:[1,0,3,2] row_mask:0xf bank_mask:0xf
    v_cndmask_b32 v48, v32, v54, vcc
    v_cndmask_b32 v49, v33, v55, vcc
    v_cndmask_b32 v50, v54, v36, vcc
    v_cndmask_b32 v51, v55, v37, vcc
    global_store_dwordx4 v9, v[48:51], s[46:47] offset:0 sc1
    v_add_f32 v40, v40, v24
    v_add_f32 v41, v41, v25
    v_add_f32 v42, v42, v26
    v_add_f32 v43, v43, v27
    v_cvt_pk_bf16_f32 v41, v40, v41
    v_cvt_pk_bf16_f32 v43, v42, v43
    v_lshlrev_b32 v40, 16, v41
    v_lshlrev_b32 v42, 16, v43
    v_and_b32 v41, 0xffff0000, v41
    v_and_b32 v43, 0xffff0000, v43
    v_add_f32 v40, v40, v136
    v_add_f32 v41, v41, v137
    v_add_f32 v42, v42, v138
    v_add_f32 v43, v43, v139
    v_cvt_pk_bf16_f32 v40, v40, v41
    v_cvt_pk_bf16_f32 v41, v42, v43
    v_add_f32 v44, v44, v28
    v_add_f32 v45, v45, v29
    v_add_f32 v46, v46, v30
    v_add_f32 v47, v47, v31
    v_cvt_pk_bf16_f32 v45, v44, v45
    v_cvt_pk_bf16_f32 v47, v46, v47
    v_lshlrev_b32 v44, 16, v45
    v_lshlrev_b32 v46, 16, v47
    v_and_b32 v45, 0xffff0000, v45
    v_and_b32 v47, 0xffff0000, v47
    v_add_f32 v44, v44, v140
    v_add_f32 v45, v45, v141
    v_add_f32 v46, v46, v142
    v_add_f32 v47, v47, v143
    v_cvt_pk_bf16_f32 v44, v44, v45
    v_cvt_pk_bf16_f32 v45, v46, v47
    v_cndmask_b32 v60, v44, v40, vcc
    v_cndmask_b32 v61, v45, v41, vcc
    s_nop 0
    v_mov_b32_dpp v62, v60 quad_perm:[1,0,3,2] row_mask:0xf bank_mask:0xf
    v_mov_b32_dpp v63, v61 quad_perm:[1,0,3,2] row_mask:0xf bank_mask:0xf
    v_cndmask_b32 v56, v40, v62, vcc
    v_cndmask_b32 v57, v41, v63, vcc
    v_cndmask_b32 v58, v62, v44, vcc
    v_cndmask_b32 v59, v63, v45, vcc
    global_store_dwordx4 v9, v[56:59], s[46:47] offset:1024 sc1
    s_waitcnt vmcnt(0)
    s_barrier
    s_cmp_lg_u32 s50, 0
    s_cbranch_scc1 L_c7
    v_mov_b32 v124, s63
    v_mov_b32 v125, 3
    s_mov_b64 exec, 1
    global_store_dword v124, v125, s[46:47] sc1
    s_mov_b64 exec, -1
L_c7:
L_end1:
    s_endpgm
.section .rodata,"a"
.p2align 6
.amdhsa_kernel gated_mix__ssm_conv_s4d__ssm_conv_s5__prompt_kernel
  .amdhsa_next_free_vgpr 256
  .amdhsa_next_free_sgpr 102
  .amdhsa_accum_offset 256
  .amdhsa_group_segment_fixed_size 0
  .amdhsa_kernarg_size 160
  .amdhsa_user_sgpr_count 2
  .amdhsa_user_sgpr_kernarg_segment_ptr 1
  .amdhsa_system_sgpr_workgroup_id_x 1
.end_amdhsa_kernel
```
